```python
import torch

def _softmax(x, axis=-1):
    return torch.softmax(x, dim=axis)
def _gelu(x):
    return torch.nn.functional.gelu(x, approximate="tanh")
def _silu(x):
    return torch.nn.functional.silu(x)
def _sigmoid(x):
    return torch.sigmoid(x)
def _layernorm(x, axis=-1, eps=1e-5):
    m = x.mean(dim=axis, keepdim=True)
    v = x.var(dim=axis, keepdim=True, unbiased=False)
    return (x - m) / torch.sqrt(v + eps)
def _scatter_add(tgt, idx, src, axis=0):
    return tgt.clone().index_add_(axis, idx, src)
def _segment_sum(src, seg, n):
    out = torch.zeros((n,) + src.shape[1:], dtype=src.dtype)
    return out.index_add_(0, seg, src)
def _pad(x, pw):
    flat = tuple(v for pair in reversed(pw) for v in pair)
    return torch.nn.functional.pad(x, flat)

kernel_name = 'standalone__dense_activation_gelu__prompt'

def setup_inputs():

    _w = (lambda a: (lambda t: t.to(torch.bfloat16) if t.is_floating_point() else t)(torch.as_tensor(a)))
    B, S, D, F = 1, 2048, 640, 1536
    return {
        "x": _w((lambda *s: torch.randn(*s, dtype=torch.bfloat16) * 0.05)(B, S, D)),
        "w1": _w((lambda *s: torch.randn(*s, dtype=torch.bfloat16) * 3.2)(D, F) * (D ** -0.5)),
        "b1": _w((lambda *s: torch.randn(*s, dtype=torch.bfloat16) * 3.2)(F) * 0.01),
        "w2": _w((lambda *s: torch.randn(*s, dtype=torch.bfloat16) * 0.05)(F, D) * (F ** -0.5)),
        "b2": _w((lambda *s: torch.randn(*s, dtype=torch.bfloat16) * 0.1)(D) * 0.01),
    }

def reference(x, w1, b1, w2, b2):
    h = torch.einsum("bsd,df->bsf", x, w1) + b1
    h = _gelu(h)
    return torch.einsum("bsf,fd->bsd", h, w2) + b2
```

```asm
; @launch grid=(256,1,1) block=(512,1,1) lds=163840
.amdgcn_target "amdgcn-amd-amdhsa--gfx950"
.text
.p2align 12
.fill 832, 4, 0xbf800000
.globl standalone__dense_activation_gelu__prompt_kernel
.p2align 8
.type standalone__dense_activation_gelu__prompt_kernel,@function
standalone__dense_activation_gelu__prompt_kernel:
    s_load_dwordx16 s[40:55], s[0:1], 0
    s_cmp_ge_u32 s2, 256
    s_cbranch_scc1 L_end
    v_lshrrev_b32 v8, 6, v0
    v_and_b32 v1, 63, v0
    v_readfirstlane_b32 s3, v8
    s_and_b32 s4, s2, 7
    s_lshr_b32 s5, s2, 3
    v_lshrrev_b32 v8, 3, v1
    v_and_b32 v9, 7, v1
    v_lshrrev_b32 v10, 1, v8
    v_mov_b32 v2, 0
    s_and_b32 s101, s3, 3
    s_mul_i32 s31, s4, 10
    s_lshr_b32 s31, s31, 3
    s_mov_b32 s10, 2621440
    s_mov_b32 s11, 0x20000
    s_mov_b32 s14, 1966080
    s_mov_b32 s15, 0x20000
    s_cmp_ge_u32 s5, 24
    s_cbranch_scc1 L_helper
    s_lshr_b32 s6, s4, 1
    s_lshl_b32 s6, s6, 2
    s_and_b32 s34, s5, 3
    s_add_u32 s6, s6, s34
    s_and_b32 s7, s4, 1
    s_mul_i32 s7, s7, 6
    s_lshr_b32 s35, s5, 2
    s_add_u32 s7, s7, s35
    s_cmp_lt_u32 s3, 4
    s_cbranch_scc1 L_c0
L_ldr:
    s_add_u32 s37, s34, s35
    s_and_b32 s37, s37, 1
    s_lshl2_add_u32 s28, s6, s101
    s_mul_i32 s28, s28, 320
    s_add_u32 s28, s28, s31
    s_and_b32 s34, s101, 1
    s_lshl1_add_u32 s34, s31, s34
    s_mul_i32 s34, s34, 768
    s_lshr_b32 s35, s101, 1
    s_lshl1_add_u32 s35, s7, s35
    s_add_u32 s34, s34, s35
    s_movk_i32 s6, 1280
    s_movk_i32 s7, 3072
    s_cmp_eq_u32 s37, 1
    s_cselect_b32 s29, s28, s34
    s_cselect_b32 s28, s34, s28
    s_cselect_b32 s34, s7, s6
    s_cselect_b32 s35, s6, s7
    s_cselect_b32 s36, s14, s10
    s_cselect_b32 s14, s10, s14
    s_mov_b32 s10, s36
    s_lshl_b32 s28, s28, 7
    s_lshl_b32 s29, s29, 7
    s_lshl2_add_u32 s30, s37, s101
    s_lshl_b32 s30, s30, 12
    s_mov_b32 m0, s30
    v_lshlrev_b32 v11, s37, v10
    v_and_b32 v11, 3, v11
    v_xor_b32 v11, v9, v11
    v_mul_u32_u24 v16, s34, v8
    v_lshl_add_u32 v16, v11, 4, v16
    s_lshl_b32 s34, s34, 3
    s_addk_i32 s34, -1024
    v_xor_b32 v17, 64, v16
    v_add_u32 v17, s34, v17
    s_lshl_b32 s34, s34, 1
    v_add_u32 v18, s34, v16
    v_add_u32 v19, s34, v17
    s_xor_b32 s36, s37, 1
    v_lshlrev_b32 v11, s36, v10
    v_and_b32 v11, 3, v11
    v_xor_b32 v11, v9, v11
    v_mul_u32_u24 v20, s35, v8
    v_lshl_add_u32 v20, v11, 4, v20
    s_lshl_b32 s35, s35, 3
    s_addk_i32 s35, -1024
    v_xor_b32 v21, 64, v20
    v_add_u32 v21, s35, v21
    s_lshl_b32 s35, s35, 1
    v_add_u32 v22, s35, v20
    v_add_u32 v23, s35, v21
    s_movk_i32 s34, 128
    s_mov_b32 s35, 196608
    s_mov_b32 s33, -1
    s_cmp_eq_u32 s37, 1
    s_cselect_b32 s6, s35, s34
    s_cselect_b32 s7, s34, s35
    s_mul_i32 s98, s6, -9
    s_mul_i32 s99, s7, -9
    s_waitcnt lgkmcnt(0)
    s_cselect_b64 s[8:9], s[42:43], s[40:41]
    s_cselect_b64 s[12:13], s[40:41], s[42:43]
L_ld:
    buffer_load_dwordx4 v16, s[8:11], s28 offen offset:0 lds
    buffer_load_dwordx4 v17, s[8:11], s28 offen offset:1024 lds
    buffer_load_dwordx4 v18, s[8:11], s28 offen offset:2048 lds
    buffer_load_dwordx4 v19, s[8:11], s28 offen offset:3072 lds
    s_xor_b32 m0, s30, 16384
    s_add_u32 s31, s31, 1
    s_cmp_eq_u32 s31, 10
    s_cselect_b32 s32, s98, s6
    s_cselect_b32 s100, s99, s7
    s_cselect_b32 s31, 0, s31
    buffer_load_dwordx4 v20, s[12:15], s29 offen offset:0 lds
    buffer_load_dwordx4 v21, s[12:15], s29 offen offset:1024 lds
    buffer_load_dwordx4 v22, s[12:15], s29 offen offset:2048 lds
    buffer_load_dwordx4 v23, s[12:15], s29 offen offset:3072 lds
    s_add_u32 s28, s28, s32
    s_add_u32 s29, s29, s100
    s_add_u32 s30, s30, 32768
    s_cmp_ge_u32 s30, 98304
    s_cselect_b32 s34, 98304, 0
    s_sub_u32 s30, s30, s34
    s_mov_b32 m0, s30
    s_add_u32 s33, s33, 1
    s_cbranch_scc1 L_ld
    s_cmp_eq_u32 s33, 3
    s_cbranch_scc1 L_su
    s_waitcnt vmcnt(8)
    s_barrier
    s_branch L_ld
L_c0:
    v_and_b32 v11, 15, v1
    v_lshlrev_b32 v13, 1, v1
    s_bfe_u32 s34, s101, 0x10000
    s_lshl1_add_u32 s36, s7, s34
    s_lshl_b32 s36, s36, 7
    s_movk_i32 s26, 3072
    s_mov_b32 s27, s11
    s_waitcnt lgkmcnt(0)
    s_mov_b64 s[24:25], s[44:45]
    buffer_load_ushort v14, v13, s[24:27], s36 offen
    s_branch L_comp
L_hl:
    s_getpc_b64 s[34:35]
    s_sub_u32 s34, s34, L_hl-standalone__dense_activation_gelu__prompt_kernel+4
    s_subb_u32 s35, s35, 0
    v_and_b32 v11, 255, v0
    v_lshlrev_b32 v11, 7, v11
    v_cmp_gt_u32 vcc, L_codeend-standalone__dense_activation_gelu__prompt_kernel, v11
    s_and_saveexec_b64 s[38:39], vcc
    s_cbranch_execz L_nocode
    s_cmp_lg_u32 s5, 24
    s_cbranch_scc1 L_nocode
    global_load_dword v40, v11, s[34:35]
L_nocode:
    s_mov_b64 exec, -1
    s_branch L_hl2
L_helper:
    s_cmp_lt_u32 s3, 4
    s_cbranch_scc0 L_hl
    v_mul_u32_u24 v16, 1280, v1
    v_mul_u32_u24 v20, 3072, v1
    s_bfe_u32 s30, s5, 0x20001
    s_and_b32 s98, s5, 1
    s_lshl_b32 s98, s98, 13
    s_add_u32 s31, s31, 1
    s_cmp_ge_u32 s31, 10
    s_cselect_b32 s34, 10, 0
    s_sub_u32 s31, s31, s34
    s_lshr_b32 s34, s4, 1
    s_lshl2_add_u32 s28, s34, s30
    s_mul_i32 s28, s28, 163840
    s_and_b32 s34, s4, 1
    s_lshl2_add_u32 s29, s34, s30
    s_mul_i32 s29, s29, 384
    s_mov_b32 s33, 1
    s_waitcnt lgkmcnt(0)
    s_mov_b64 s[8:9], s[40:41]
    s_mov_b64 s[12:13], s[42:43]
    s_cmp_ge_u32 s3, 1
    s_cbranch_scc1 L_pfe
L_pf:
    s_mul_i32 s34, s31, 196608
    s_add_u32 s34, s34, s29
    v_add3_u32 v97, s34, v20, 0
    v_and_b32 v98, 8192, v97
    v_cmpx_eq_u32 vcc, s98, v98
    buffer_load_dword v96, v97, s[12:15], 0 offen
    s_mov_b64 exec, -1
    v_add_u32 v97, 128, v97
    v_and_b32 v98, 8192, v97
    v_cmpx_eq_u32 vcc, s98, v98
    buffer_load_dword v96, v97, s[12:15], 0 offen
    s_mov_b64 exec, -1
    v_add_u32 v97, 128, v97
    v_and_b32 v98, 8192, v97
    v_cmpx_eq_u32 vcc, s98, v98
    buffer_load_dword v96, v97, s[12:15], 0 offen
    s_mov_b64 exec, -1
    s_lshl_b32 s34, s31, 7
    s_add_u32 s34, s34, s28
    v_add3_u32 v97, s34, v16, 0
    v_and_b32 v98, 8192, v97
    v_cmpx_eq_u32 vcc, s98, v98
    buffer_load_dword v96, v97, s[8:11], 0 offen
    s_mov_b64 exec, -1
    v_add_u32 v97, 81920, v97
    v_and_b32 v98, 8192, v97
    v_cmpx_eq_u32 vcc, s98, v98
    buffer_load_dword v96, v97, s[8:11], 0 offen
    s_mov_b64 exec, -1
    s_xor_b32 s98, s98, 8192
    s_add_u32 s31, s31, 1
    s_cmp_eq_u32 s31, 10
    s_cselect_b32 s31, 0, s31
    s_add_u32 s33, s33, 1
    s_cmp_lt_u32 s33, 10
    s_cbranch_scc1 L_pf
L_pfe:
L_hc2:
    s_getpc_b64 s[34:35]
L_t2:
    s_add_u32 s34, s34, L_table-L_t2
    s_addc_u32 s35, s35, 0
    s_lshl_b32 s83, s2, 2
    s_load_dword s83, s[34:35], s83
    s_mov_b64 s[16:17], s[46:47]
    s_mov_b32 s18, 1966080
    s_mov_b32 s19, 0x20000
    s_cmp_ge_u32 s3, 1
    s_cbranch_scc1 L_pf2e
    s_and_b32 s29, s4, 1
    s_mul_i32 s29, s29, 640
    s_mul_i32 s34, s30, 491520
    s_add_u32 s29, s29, s34
    s_lshr_b32 s37, s4, 1
    s_cmp_eq_u32 s37, 3
    s_cselect_b32 s37, 0, s37
    s_lshl_b32 s37, s37, 1
    s_mov_b32 s31, 0x110
    s_mov_b32 s33, 0
    s_cmp_eq_u32 s30, 0
    s_cselect_b32 s28, 3, 2
    s_cmp_eq_u32 s30, 3
    s_cselect_b32 s28, 1, s28
L_pf2:
    s_and_b32 s34, s31, 15
    s_lshr_b32 s31, s31, 4
    s_add_u32 s34, s34, s37
    s_cmp_ge_u32 s34, 6
    s_cselect_b32 s36, 6, 0
    s_sub_u32 s34, s34, s36
    s_mul_i32 s34, s34, 81920
    s_add_u32 s34, s34, s29
    v_add3_u32 v97, s34, v16, 0
    v_and_b32 v98, 8192, v97
    v_cmpx_eq_u32 vcc, s98, v98
    buffer_load_dword v96, v97, s[16:19], 0 offen
    s_mov_b64 exec, -1
    v_add_u32 v97, 128, v97
    v_and_b32 v98, 8192, v97
    v_cmpx_eq_u32 vcc, s98, v98
    buffer_load_dword v96, v97, s[16:19], 0 offen
    s_mov_b64 exec, -1
    v_add_u32 v97, 128, v97
    v_and_b32 v98, 8192, v97
    v_cmpx_eq_u32 vcc, s98, v98
    buffer_load_dword v96, v97, s[16:19], 0 offen
    s_mov_b64 exec, -1
    v_add_u32 v97, 128, v97
    v_and_b32 v98, 8192, v97
    v_cmpx_eq_u32 vcc, s98, v98
    buffer_load_dword v96, v97, s[16:19], 0 offen
    s_mov_b64 exec, -1
    v_add_u32 v97, 128, v97
    v_and_b32 v98, 8192, v97
    v_cmpx_eq_u32 vcc, s98, v98
    buffer_load_dword v96, v97, s[16:19], 0 offen
    s_mov_b64 exec, -1
    s_add_u32 s33, s33, 1
    s_xor_b32 s98, s98, 8192
    s_cmp_eq_u32 s33, 2
    s_cselect_b32 s34, 1474560, 0
    s_add_u32 s29, s29, s34
    s_cmp_lt_u32 s33, s28
    s_cbranch_scc1 L_pf2
L_pf2e:
    s_barrier
    s_branch L_red
L_hl2:
    s_memrealtime s[56:57]
    v_lshlrev_b32 v12, 2, v1
    v_add_u32 v12, 156672, v12
    ds_write_b32 v12, v2 offset:0
    ds_write_b32 v12, v2 offset:256
    ds_write_b32 v12, v2 offset:512
    ds_write_b32 v12, v2 offset:768
    ds_write_b32 v12, v2 offset:1024
    s_waitcnt lgkmcnt(0)
    s_mov_b64 s[8:9], s[40:41]
    s_mov_b64 s[12:13], s[42:43]
    v_mov_b32 v16, 0
    v_mov_b32 v17, 0
    v_mov_b32 v18, 0
    v_mov_b32 v19, 0
    v_mov_b32 v20, 0
    v_mov_b32 v21, 0
    v_mov_b32 v22, 0
    v_mov_b32 v23, 0
    s_cmp_lg_u32 s2, 255
    s_cbranch_scc1 L_nolead
    s_sub_u32 s20, 0, s54
    s_and_b32 s20, s20, 0x1fffff
    s_add_u32 s20, s54, s20
    s_addc_u32 s21, s55, 0
    s_lshl_b32 s34, s101, 2
    s_add_u32 s34, s34, 157952
    v_mov_b32 v11, s34
    ds_write_b32 v11, v2
    s_mov_b64 s[22:23], 0
    s_cmp_lg_u32 s101, 0
    s_cbranch_scc1 L_noclr
    s_atomic_swap_x2 s[22:23], s[52:53], 0
L_noclr:
    s_lshl_b32 s34, s101, 21
    s_add_u32 s34, s34, 105472
    s_add_u32 s35, s34, 8192
    s_load_dword s24, s[20:21], s34 glc
    s_load_dword s25, s[20:21], s35 glc
    s_mov_b32 s26, -1
    s_mov_b32 s27, -1
    s_mov_b32 s33, 0
    s_waitcnt lgkmcnt(0)
L_pr:
    s_memtime s[16:17]
    s_load_dword s24, s[20:21], s34 glc
    s_waitcnt lgkmcnt(0)
    s_memtime s[18:19]
    s_waitcnt lgkmcnt(0)
    s_sub_u32 s25, s18, s16
    s_min_u32 s26, s26, s25
    s_memtime s[16:17]
    s_load_dword s24, s[20:21], s35 glc
    s_waitcnt lgkmcnt(0)
    s_memtime s[18:19]
    s_waitcnt lgkmcnt(0)
    s_sub_u32 s25, s18, s16
    s_min_u32 s27, s27, s25
    s_add_u32 s33, s33, 1
    s_cmp_lt_u32 s33, 2
    s_cbranch_scc1 L_pr
    s_cmp_ge_u32 s33, 5
    s_cbranch_scc1 L_pre
    s_min_u32 s24, s26, s27
    s_max_u32 s25, s26, s27
    s_mul_i32 s24, s24, 22
    s_lshl_b32 s25, s25, 4
    s_cmp_lt_u32 s25, s24
    s_cbranch_scc1 L_pr
L_pre:
    s_cmp_lt_u32 s27, s26
    s_cselect_b32 s34, 2, 1
    v_mov_b32 v12, s34
    ds_write_b32 v11, v12
    s_cmp_lg_u32 s101, 0
    s_cbranch_scc1 L_nolead
    v_and_b32 v12, 3, v1
    v_lshl_add_u32 v11, v12, 2, v11
L_pc:
    ds_read_b32 v12, v11
    s_add_u32 s33, s33, 1
    s_cmp_gt_u32 s33, 1000
    s_waitcnt lgkmcnt(0)
    s_cbranch_scc1 L_pc_x
    v_cmp_eq_u32 vcc, 0, v12
    s_cbranch_vccnz L_pc
L_pc_x:
    v_cmp_eq_u32 vcc, 2, v12
    s_and_b32 s57, s57, 0xffffff
    s_bitset1_b32 s57, 30
    s_nop 1
    s_getreg_b32 s35, hwreg(HW_REG_XCC_ID)
    s_bitcmp1_b32 s35, 1
    s_cselect_b32 s35, 0, 3
    s_and_b32 s34, vcc_lo, 15
    s_xor_b32 s34, s34, s35
    s_lshl_b32 s34, s34, 24
    s_or_b32 s57, s57, s34
    s_atomic_swap_x2 s[56:57], s[52:53], 0
L_nolead:
L_su:
    s_getpc_b64 s[34:35]
L_t0:
    s_add_u32 s34, s34, L_table-L_t0
    s_addc_u32 s35, s35, 0
    s_lshl_b32 s83, s2, 2
    s_load_dword s83, s[34:35], s83
    v_lshlrev_b32 v11, 1, v10
    v_xor_b32 v11, v9, v11
    v_mul_u32_u24 v24, 1280, v8
    v_lshl_add_u32 v24, v11, 4, v24
    v_add_u32 v25, 9216, v24
    v_add_u32 v26, 18432, v24
    v_add_u32 v27, 27648, v24
    s_lshr_b32 s37, s4, 1
    s_cmp_eq_u32 s37, 3
    s_cselect_b32 s37, 0, s37
    s_mul_i32 s94, s101, 4352
    s_add_u32 s94, s94, 87040
    v_lshrrev_b32 v11, 2, v1
    v_lshlrev_b32 v11, 7, v11
    v_bfe_u32 v12, v1, 3, 2
    v_lshl_add_u32 v11, v12, 5, v11
    v_and_b32 v12, 3, v1
    v_lshl_add_u32 v11, v12, 3, v11
    v_add_u32 v56, s94, v11
    v_xor_b32 v57, 32, v56
    v_xor_b32 v58, 64, v56
    v_xor_b32 v59, 96, v56
    v_lshlrev_b32 v0, 4, v1
    s_mul_i32 s36, s101, 3
    s_add_u32 s88, s36, s37
    s_add_u32 s89, s88, 1
    s_cmp_eq_u32 s37, 2
    s_cselect_b32 s89, s36, s89
    s_add_u32 s90, s89, 1
    s_cmp_eq_u32 s37, 1
    s_cselect_b32 s90, s36, s90
    s_and_b32 s34, s88, 14
    s_add_u32 s88, s88, s34
    s_lshl_b32 s88, s88, 12
    s_and_b32 s34, s89, 14
    s_add_u32 s89, s89, s34
    s_lshl_b32 s89, s89, 12
    s_and_b32 s34, s90, 14
    s_add_u32 s90, s90, s34
    s_lshl_b32 s90, s90, 12
    v_and_b32 v11, 15, v1
    v_lshrrev_b32 v12, 4, v1
    v_mul_u32_u24 v6, 272, v11
    v_lshl_add_u32 v6, v12, 4, v6
    s_mul_i32 s34, s101, 4352
    v_add_u32 v6, s34, v6
    s_lshl_b32 s34, s101, 8
    s_add_u32 s34, s34, 156928
    v_lshl_add_u32 v7, v1, 2, s34
    s_waitcnt lgkmcnt(0)
    s_and_b32 s92, s83, 15
    s_bfe_u32 s58, s83, 0x70004
    s_bfe_u32 s59, s83, 0x3000b
    s_lshr_b32 s83, s83, 14
    s_mul_i32 s97, s101, 491520
    s_lshl_b32 s34, s92, 7
    s_add_u32 s97, s97, s34
    s_mul_i32 s34, s37, 163840
    s_add_u32 s93, s97, s34
    s_add_u32 s1, s58, s59
    s_and_b32 s0, s83, 7
    s_add_u32 s0, s0, s58
    s_mov_b64 s[24:25], s[52:53]
    s_mov_b32 s26, 256
    s_mov_b32 s27, 0x20000
    s_cmp_eq_u32 s101, 0
    s_cselect_b32 s56, 8, -1
    s_cmp_lt_u32 s5, 24
    s_cbranch_scc1 L_ld2w
    s_barrier
    buffer_load_dwordx2 v[4:5], v2, s[24:27], 0 offen sc1
    s_branch L_lw
L_ld2:
    buffer_load_dwordx4 v16, s[8:11], s28 offen offset:0 lds
    buffer_load_dwordx4 v17, s[8:11], s28 offen offset:1024 lds
    buffer_load_dwordx4 v18, s[8:11], s28 offen offset:2048 lds
    buffer_load_dwordx4 v19, s[8:11], s28 offen offset:3072 lds
    s_xor_b32 m0, s30, 16384
    s_add_u32 s31, s31, 1
    s_cmp_eq_u32 s31, 10
    s_cselect_b32 s32, s98, s6
    s_cselect_b32 s100, s99, s7
    s_cselect_b32 s31, 0, s31
    buffer_load_dwordx4 v20, s[12:15], s29 offen offset:0 lds
    buffer_load_dwordx4 v21, s[12:15], s29 offen offset:1024 lds
    buffer_load_dwordx4 v22, s[12:15], s29 offen offset:2048 lds
    buffer_load_dwordx4 v23, s[12:15], s29 offen offset:3072 lds
    s_add_u32 s28, s28, s32
    s_add_u32 s29, s29, s100
    s_add_u32 s30, s30, 32768
    s_cmp_ge_u32 s30, 98304
    s_cselect_b32 s34, 98304, 0
    s_sub_u32 s30, s30, s34
    s_mov_b32 m0, s30
    s_add_u32 s33, s33, 1
    s_cmp_lg_u32 s33, s56
    s_cbranch_scc1 L_ld2w
    buffer_load_dwordx2 v[4:5], v2, s[24:27], 0 offen sc1
L_ld2w:
    s_cmp_lt_u32 s33, 9
    s_waitcnt vmcnt(8)
    s_barrier
    s_cbranch_scc1 L_ld2
    s_branch L_lw
L_comp:
    s_getpc_b64 s[34:35]
L_t1:
    s_add_u32 s34, s34, L_table-L_t1
    s_addc_u32 s35, s35, 0
    s_lshl_b32 s83, s2, 2
    s_load_dword s83, s[34:35], s83
    v_mov_b32 v97, 0
    v_mov_b32 v98, 0
    v_mov_b32 v99, 0
    v_mov_b32 v101, 0
    v_mov_b32 v102, 0
    v_mov_b32 v103, 0
    v_mov_b32 v105, 0
    v_mov_b32 v106, 0
    v_mov_b32 v107, 0
    v_mov_b32 v109, 0
    v_mov_b32 v110, 0
    v_mov_b32 v111, 0
    v_mov_b32 v29, 0
    v_mov_b32 v30, 0
    v_mov_b32 v31, 0
    v_lshrrev_b32 v3, 4, v1
    v_mov_b32 v13, 0x3f80
    v_cmp_eq_u32 vcc, 0, v3
    s_lshr_b32 s34, s101, 1
    s_lshl_b32 s34, s34, 6
    v_add_u32 v11, s34, v11
    v_lshlrev_b32 v11, 7, v11
    v_bfe_u32 v12, v1, 1, 3
    v_xor_b32 v12, v12, v3
    v_lshl_add_u32 v16, v12, 4, v11
    v_xor_b32 v17, 64, v16
    v_bfe_u32 v11, v1, 2, 2
    v_lshl_add_u32 v11, v3, 3, v11
    v_lshlrev_b32 v11, 7, v11
    v_bfe_u32 v12, v1, 3, 2
    v_lshl_add_u32 v11, v12, 5, v11
    v_and_b32 v12, 3, v1
    v_lshl_add_u32 v11, v12, 3, v11
    s_and_b32 s34, s101, 1
    s_lshl_b32 s34, s34, 13
    s_add_u32 s34, s34, 16384
    v_add_u32 v18, s34, v11
    v_xor_b32 v19, 32, v18
    v_xor_b32 v20, 64, v18
    v_xor_b32 v21, 96, v18
    v_lshlrev_b32 v12, 2, v1
    v_add_u32 v12, 156672, v12
    ds_write_b32 v12, v2 offset:0
    ds_write_b32 v12, v2 offset:256
    ds_write_b32 v12, v2 offset:512
    ds_write_b32 v12, v2 offset:768
    ds_write_b32 v12, v2 offset:1024
    v_mov_b32 v28, 0x3f80
    v_cmp_eq_u32 s[8:9], 0, v3
    v_cmp_eq_u32 s[10:11], 1, v3
    v_cmp_eq_u32 s[12:13], 2, v3
    v_cmp_eq_u32 s[14:15], 3, v3
    v_mov_b32 v22, 0xc0135761
    v_mov_b32 v23, v22
    v_mov_b32 v24, 1.0
    v_mov_b32 v25, 1.0
    s_mov_b32 s38, 0xbdd2d3e8
    s_mov_b32 s39, s38
    s_sub_u32 s20, 0, s54
    s_and_b32 s20, s20, 0x1fffff
    s_add_u32 s20, s54, s20
    s_addc_u32 s21, s55, 0
    s_mov_b32 s22, 8388608
    s_mov_b32 s23, 0x20000
    s_and_b32 s93, s6, 7
    s_lshl_b32 s93, s93, 20
    s_and_b32 s34, s101, 2
    s_lshl_b32 s34, s34, 18
    s_add_u32 s28, s93, s34
    s_lshl_b32 s34, s36, 1
    s_add_u32 s29, s28, s34
    s_add_u32 s29, s29, 114688
    s_lshl_b32 s36, s36, 4
    s_and_b32 s34, s36, 0xe000
    s_add_u32 s36, s36, s34
    s_add_u32 s28, s28, s36
    s_lshl_b32 s34, s7, 9
    s_add_u32 s93, s93, s34
    s_add_u32 s93, s93, 98304
    v_lshlrev_b32 v26, 4, v1
    v_mov_b32 v8, 1
    v_mov_b32 v9, 156672
    v_lshlrev_b32 v10, 3, v1
    s_mov_b32 s37, 0
    s_mov_b32 s33, 0
    s_mov_b32 s100, 4294901760
    s_setprio 1
    s_waitcnt vmcnt(0) lgkmcnt(0)
    v_cndmask_b32 v96, 0, v14, s[8:9]
    v_cndmask_b32 v100, 0, v14, s[10:11]
    v_cndmask_b32 v104, 0, v14, s[12:13]
    v_cndmask_b32 v108, 0, v14, s[14:15]
    v_mfma_f32_16x16x32_bf16 v[32:35], v[96:99], v[28:31], 0
    v_mfma_f32_16x16x32_bf16 v[36:39], v[100:103], v[28:31], 0
    v_mfma_f32_16x16x32_bf16 v[40:43], v[104:107], v[28:31], 0
    v_mfma_f32_16x16x32_bf16 v[44:47], v[108:111], v[28:31], 0
    v_mfma_f32_16x16x32_bf16 v[48:51], v[96:99], v[28:31], 0
    v_mfma_f32_16x16x32_bf16 v[52:55], v[100:103], v[28:31], 0
    v_mfma_f32_16x16x32_bf16 v[56:59], v[104:107], v[28:31], 0
    v_mfma_f32_16x16x32_bf16 v[60:63], v[108:111], v[28:31], 0
    v_mfma_f32_16x16x32_bf16 v[64:67], v[96:99], v[28:31], 0
    v_mfma_f32_16x16x32_bf16 v[68:71], v[100:103], v[28:31], 0
    v_mfma_f32_16x16x32_bf16 v[72:75], v[104:107], v[28:31], 0
    v_mfma_f32_16x16x32_bf16 v[76:79], v[108:111], v[28:31], 0
    v_mfma_f32_16x16x32_bf16 v[80:83], v[96:99], v[28:31], 0
    v_mfma_f32_16x16x32_bf16 v[84:87], v[100:103], v[28:31], 0
    v_mfma_f32_16x16x32_bf16 v[88:91], v[104:107], v[28:31], 0
    v_mfma_f32_16x16x32_bf16 v[92:95], v[108:111], v[28:31], 0
    s_branch L_c2
    .p2align 12
L_lw:
    s_mov_b64 s[16:17], s[46:47]
    s_mov_b32 s18, 1966080
    s_mov_b32 s19, 0x20000
    s_add_u32 m0, s94, 17408
    s_nop 0
    buffer_load_dwordx4 v24, s[16:19], s93 offen offset:0 lds
    buffer_load_dwordx4 v25, s[16:19], s93 offen offset:1024 lds
    buffer_load_dwordx4 v26, s[16:19], s93 offen offset:2048 lds
    buffer_load_dwordx4 v27, s[16:19], s93 offen offset:3072 lds
    s_add_u32 s93, s93, 40960
    v_mov_b32 v13, 156680
    s_cmp_ge_u32 s5, 24
    s_cbranch_scc1 L_cb0
    s_cmp_lg_u32 s101, 0
    s_cbranch_scc1 L_cb0
    s_mov_b32 s33, 0
L_n0:
    v_readfirstlane_b32 s56, v4
    v_readfirstlane_b32 s57, v5
    s_add_u32 s33, s33, 1
    s_nop 1
    s_bitcmp1_b32 s57, 30
    s_cbranch_scc1 L_n0_ok
    s_cmp_gt_u32 s33, 1000000
    s_cbranch_scc1 L_n0_ok
    buffer_load_dwordx2 v[4:5], v2, s[24:27], 0 offen sc1
    s_waitcnt vmcnt(0)
    s_branch L_n0
L_n0_ok:
    ds_write_b64 v13, v[4:5]
L_cb0:
    s_sub_u32 s20, 0, s54
    s_and_b32 s20, s20, 0x1fffff
    s_add_u32 s20, s54, s20
    s_addc_u32 s21, s55, 0
    s_mov_b32 s22, 8388608
    s_mov_b32 s23, 0x20000
    s_waitcnt vmcnt(4) lgkmcnt(0)
    s_cmp_ge_u32 s5, 24
    s_cbranch_scc1 L_cb1
    s_barrier
    ds_read_b64 v[4:5], v13
L_cb1:
    s_setprio 0
    s_add_u32 m0, s94, 34816
    s_nop 0
    buffer_load_dwordx4 v24, s[16:19], s93 offen offset:0 lds
    buffer_load_dwordx4 v25, s[16:19], s93 offen offset:1024 lds
    buffer_load_dwordx4 v26, s[16:19], s93 offen offset:2048 lds
    buffer_load_dwordx4 v27, s[16:19], s93 offen offset:3072 lds
    s_add_u32 s93, s93, 40960
    s_waitcnt vmcnt(4)
    s_waitcnt lgkmcnt(0)
    ds_read_b64_tr_b16 a[0:1], v56 offset:17408
    ds_read_b64_tr_b16 a[2:3], v56 offset:19456
    ds_read_b64_tr_b16 a[4:5], v57 offset:17408
    ds_read_b64_tr_b16 a[6:7], v57 offset:19456
    ds_read_b64_tr_b16 a[8:9], v58 offset:17408
    ds_read_b64_tr_b16 a[10:11], v58 offset:19456
    ds_read_b64_tr_b16 a[12:13], v59 offset:17408
    ds_read_b64_tr_b16 a[14:15], v59 offset:19456
    s_add_u32 m0, s94, 52224
    s_nop 0
    buffer_load_dwordx4 v24, s[16:19], s93 offen offset:0 lds
    buffer_load_dwordx4 v25, s[16:19], s93 offen offset:1024 lds
    buffer_load_dwordx4 v26, s[16:19], s93 offen offset:2048 lds
    buffer_load_dwordx4 v27, s[16:19], s93 offen offset:3072 lds
    s_add_u32 s93, s93, 40960
    s_waitcnt vmcnt(4)
    s_waitcnt lgkmcnt(0)
    ds_read_b64_tr_b16 a[16:17], v56 offset:34816
    ds_read_b64_tr_b16 a[18:19], v56 offset:36864
    ds_read_b64_tr_b16 a[20:21], v57 offset:34816
    ds_read_b64_tr_b16 a[22:23], v57 offset:36864
    ds_read_b64_tr_b16 a[24:25], v58 offset:34816
    ds_read_b64_tr_b16 a[26:27], v58 offset:36864
    ds_read_b64_tr_b16 a[28:29], v59 offset:34816
    ds_read_b64_tr_b16 a[30:31], v59 offset:36864
    s_add_u32 m0, s94, 17408
    s_nop 0
    buffer_load_dwordx4 v24, s[16:19], s93 offen offset:0 lds
    buffer_load_dwordx4 v25, s[16:19], s93 offen offset:1024 lds
    buffer_load_dwordx4 v26, s[16:19], s93 offen offset:2048 lds
    buffer_load_dwordx4 v27, s[16:19], s93 offen offset:3072 lds
    s_add_u32 s93, s93, 40960
    s_cmp_eq_u32 s37, 2
    s_cselect_b32 s93, s97, s93
    s_waitcnt vmcnt(4)
    s_waitcnt lgkmcnt(0)
    ds_read_b64_tr_b16 a[32:33], v56 offset:52224
    ds_read_b64_tr_b16 a[34:35], v56 offset:54272
    ds_read_b64_tr_b16 a[36:37], v57 offset:52224
    ds_read_b64_tr_b16 a[38:39], v57 offset:54272
    ds_read_b64_tr_b16 a[40:41], v58 offset:52224
    ds_read_b64_tr_b16 a[42:43], v58 offset:54272
    ds_read_b64_tr_b16 a[44:45], v59 offset:52224
    ds_read_b64_tr_b16 a[46:47], v59 offset:54272
    s_cmp_ge_u32 s5, 24
    s_cbranch_scc1 L_gp4
    s_waitcnt vmcnt(1)
L_gp4:
    s_add_u32 m0, s94, 34816
    s_nop 0
    buffer_load_dwordx4 v24, s[16:19], s93 offen offset:0 lds
    buffer_load_dwordx4 v25, s[16:19], s93 offen offset:1024 lds
    buffer_load_dwordx4 v26, s[16:19], s93 offen offset:2048 lds
    buffer_load_dwordx4 v27, s[16:19], s93 offen offset:3072 lds
    s_add_u32 s93, s93, 40960
    s_mov_b32 s33, 0
L_n1:
    v_readfirstlane_b32 s56, v4
    v_readfirstlane_b32 s57, v5
    s_add_u32 s33, s33, 1
    s_nop 1
    s_bitcmp1_b32 s57, 30
    s_cbranch_scc1 L_n1_ok
    s_cmp_gt_u32 s33, 1000000
    s_cbranch_scc1 L_n1_ok
    buffer_load_dwordx2 v[4:5], v2, s[24:27], 0 offen sc1
    s_waitcnt vmcnt(0)
    s_branch L_n1
L_n1_ok:
    s_bfe_u32 s63, s57, 0x40018
    s_mul_i32 s63, s63, 17
    s_xor_b32 s63, s63, 15
    s_lshl_b32 s63, s63, 13
    s_mul_i32 s36, s101, 3
    s_and_b32 s91, s58, 0x78
    s_lshr_b32 s34, s91, 4
    s_lshr_b32 s34, s63, s34
    s_and_b32 s34, s34, 8192
    s_and_b32 s82, s91, 63
    s_lshl_b32 s82, s82, 17
    s_or_b32 s82, s82, s34
    s_sub_u32 s91, s1, 1
    s_and_b32 s91, s91, 0x78
    s_lshr_b32 s34, s91, 4
    s_lshr_b32 s34, s63, s34
    s_and_b32 s34, s34, 8192
    s_and_b32 s35, s91, 63
    s_lshl_b32 s35, s35, 17
    s_or_b32 s35, s35, s34
    v_mov_b32 v11, s82
    v_mov_b32 v12, s35
    v_cmp_lt_u32 vcc, 31, v1
    v_bfe_u32 v3, v1, 3, 2
    v_min_u32 v3, 2, v3
    v_add_u32 v3, s36, v3
    v_cndmask_b32 v11, v11, v12, vcc
    v_lshl_add_u32 v3, v3, 9, v11
    v_add_u32 v3, 98304, v3
    s_lshr_b32 s34, s0, 4
    s_lshr_b32 s34, s63, s34
    s_and_b32 s34, s34, 8192
    s_and_b32 s82, s0, 63
    s_lshl_b32 s82, s82, 17
    s_or_b32 s82, s82, s34
    s_add_u32 s95, s82, s88
    s_mov_b32 s91, 0
    s_mov_b32 s96, 0
    s_lshl_b32 s34, s36, 9
    s_add_u32 s34, s34, s82
    s_add_u32 s34, s34, 114688
    v_min_u32 v62, 5, v8
    v_lshl_add_u32 v62, v62, 8, s34
    s_mov_b32 s28, s34
    s_waitcnt vmcnt(4)
    s_waitcnt lgkmcnt(0)
    ds_read_b64_tr_b16 a[48:49], v56 offset:17408
    ds_read_b64_tr_b16 a[50:51], v56 offset:19456
    ds_read_b64_tr_b16 a[52:53], v57 offset:17408
    ds_read_b64_tr_b16 a[54:55], v57 offset:19456
    ds_read_b64_tr_b16 a[56:57], v58 offset:17408
    ds_read_b64_tr_b16 a[58:59], v58 offset:19456
    ds_read_b64_tr_b16 a[60:61], v59 offset:17408
    ds_read_b64_tr_b16 a[62:63], v59 offset:19456
    s_cmp_ge_u32 s5, 24
    s_cbranch_scc1 L_gp5
    s_waitcnt vmcnt(1)
L_gp5:
    s_add_u32 m0, s94, 52224
    s_nop 0
    buffer_load_dwordx4 v24, s[16:19], s93 offen offset:0 lds
    buffer_load_dwordx4 v25, s[16:19], s93 offen offset:1024 lds
    buffer_load_dwordx4 v26, s[16:19], s93 offen offset:2048 lds
    buffer_load_dwordx4 v27, s[16:19], s93 offen offset:3072 lds
    s_add_u32 s93, s93, 40960
    s_waitcnt vmcnt(4)
    s_waitcnt lgkmcnt(0)
    ds_read_b64_tr_b16 a[64:65], v56 offset:34816
    ds_read_b64_tr_b16 a[66:67], v56 offset:36864
    ds_read_b64_tr_b16 a[68:69], v57 offset:34816
    ds_read_b64_tr_b16 a[70:71], v57 offset:36864
    ds_read_b64_tr_b16 a[72:73], v58 offset:34816
    ds_read_b64_tr_b16 a[74:75], v58 offset:36864
    ds_read_b64_tr_b16 a[76:77], v59 offset:34816
    ds_read_b64_tr_b16 a[78:79], v59 offset:36864
    s_cmp_ge_u32 s5, 24
    s_cbranch_scc1 L_gp6
    s_waitcnt vmcnt(1)
L_gp6:
    s_add_u32 m0, s94, 17408
    s_nop 0
    buffer_load_dwordx4 v24, s[16:19], s93 offen offset:0 lds
    buffer_load_dwordx4 v25, s[16:19], s93 offen offset:1024 lds
    buffer_load_dwordx4 v26, s[16:19], s93 offen offset:2048 lds
    buffer_load_dwordx4 v27, s[16:19], s93 offen offset:3072 lds
    s_add_u32 s93, s93, 40960
    s_waitcnt vmcnt(4)
    s_waitcnt lgkmcnt(0)
    ds_read_b64_tr_b16 a[80:81], v56 offset:52224
    ds_read_b64_tr_b16 a[82:83], v56 offset:54272
    ds_read_b64_tr_b16 a[84:85], v57 offset:52224
    ds_read_b64_tr_b16 a[86:87], v57 offset:54272
    ds_read_b64_tr_b16 a[88:89], v58 offset:52224
    ds_read_b64_tr_b16 a[90:91], v58 offset:54272
    ds_read_b64_tr_b16 a[92:93], v59 offset:52224
    ds_read_b64_tr_b16 a[94:95], v59 offset:54272
    s_cmp_ge_u32 s5, 24
    s_cbranch_scc1 L_gp7
    s_waitcnt vmcnt(1)
L_gp7:
    s_add_u32 m0, s94, 34816
    s_nop 0
    buffer_load_dwordx4 v24, s[16:19], s93 offen offset:0 lds
    buffer_load_dwordx4 v25, s[16:19], s93 offen offset:1024 lds
    buffer_load_dwordx4 v26, s[16:19], s93 offen offset:2048 lds
    buffer_load_dwordx4 v27, s[16:19], s93 offen offset:3072 lds
    s_add_u32 s93, s93, 40960
    s_cmp_eq_u32 s37, 1
    s_cselect_b32 s93, s97, s93
    s_waitcnt vmcnt(4)
    s_waitcnt lgkmcnt(0)
    ds_read_b64_tr_b16 a[96:97], v56 offset:17408
    ds_read_b64_tr_b16 a[98:99], v56 offset:19456
    ds_read_b64_tr_b16 a[100:101], v57 offset:17408
    ds_read_b64_tr_b16 a[102:103], v57 offset:19456
    ds_read_b64_tr_b16 a[104:105], v58 offset:17408
    ds_read_b64_tr_b16 a[106:107], v58 offset:19456
    ds_read_b64_tr_b16 a[108:109], v59 offset:17408
    ds_read_b64_tr_b16 a[110:111], v59 offset:19456
    s_cmp_ge_u32 s5, 24
    s_cbranch_scc1 L_gp8
    s_waitcnt vmcnt(1)
L_gp8:
    s_add_u32 m0, s94, 52224
    s_nop 0
    buffer_load_dwordx4 v24, s[16:19], s93 offen offset:0 lds
    buffer_load_dwordx4 v25, s[16:19], s93 offen offset:1024 lds
    buffer_load_dwordx4 v26, s[16:19], s93 offen offset:2048 lds
    buffer_load_dwordx4 v27, s[16:19], s93 offen offset:3072 lds
    s_add_u32 s93, s93, 40960
    s_waitcnt vmcnt(4)
    s_waitcnt lgkmcnt(0)
    ds_read_b64_tr_b16 a[112:113], v56 offset:34816
    ds_read_b64_tr_b16 a[114:115], v56 offset:36864
    ds_read_b64_tr_b16 a[116:117], v57 offset:34816
    ds_read_b64_tr_b16 a[118:119], v57 offset:36864
    ds_read_b64_tr_b16 a[120:121], v58 offset:34816
    ds_read_b64_tr_b16 a[122:123], v58 offset:36864
    ds_read_b64_tr_b16 a[124:125], v59 offset:34816
    ds_read_b64_tr_b16 a[126:127], v59 offset:36864
    s_add_u32 m0, s94, 17408
    s_nop 0
    buffer_load_dwordx4 v24, s[16:19], s93 offen offset:0 lds
    buffer_load_dwordx4 v25, s[16:19], s93 offen offset:1024 lds
    buffer_load_dwordx4 v26, s[16:19], s93 offen offset:2048 lds
    buffer_load_dwordx4 v27, s[16:19], s93 offen offset:3072 lds
    s_add_u32 s93, s93, 40960
    s_waitcnt vmcnt(4)
    s_waitcnt lgkmcnt(0)
    ds_read_b64_tr_b16 v[64:65], v56 offset:52224
    ds_read_b64_tr_b16 v[66:67], v56 offset:54272
    ds_read_b64_tr_b16 v[68:69], v57 offset:52224
    ds_read_b64_tr_b16 v[70:71], v57 offset:54272
    ds_read_b64_tr_b16 v[72:73], v58 offset:52224
    ds_read_b64_tr_b16 v[74:75], v58 offset:54272
    ds_read_b64_tr_b16 v[76:77], v59 offset:52224
    ds_read_b64_tr_b16 v[78:79], v59 offset:54272
    s_add_u32 m0, s94, 34816
    s_nop 0
    buffer_load_dwordx4 v24, s[16:19], s93 offen offset:0 lds
    buffer_load_dwordx4 v25, s[16:19], s93 offen offset:1024 lds
    buffer_load_dwordx4 v26, s[16:19], s93 offen offset:2048 lds
    buffer_load_dwordx4 v27, s[16:19], s93 offen offset:3072 lds
    s_add_u32 s93, s93, 40960
    s_cmp_ge_u32 s5, 24
    s_cbranch_scc1 L_pg1
    buffer_load_dwordx2 v[4:5], v62, s[20:23], 0 offen sc1
L_pg1:
    s_waitcnt vmcnt(4)
    s_waitcnt lgkmcnt(0)
    ds_read_b64_tr_b16 v[80:81], v56 offset:17408
    ds_read_b64_tr_b16 v[82:83], v56 offset:19456
    ds_read_b64_tr_b16 v[84:85], v57 offset:17408
    ds_read_b64_tr_b16 v[86:87], v57 offset:19456
    ds_read_b64_tr_b16 v[88:89], v58 offset:17408
    ds_read_b64_tr_b16 v[90:91], v58 offset:19456
    ds_read_b64_tr_b16 v[92:93], v59 offset:17408
    ds_read_b64_tr_b16 v[94:95], v59 offset:19456
    s_add_u32 m0, s94, 52224
    s_nop 0
    buffer_load_dwordx4 v24, s[16:19], s93 offen offset:0 lds
    buffer_load_dwordx4 v25, s[16:19], s93 offen offset:1024 lds
    buffer_load_dwordx4 v26, s[16:19], s93 offen offset:2048 lds
    buffer_load_dwordx4 v27, s[16:19], s93 offen offset:3072 lds
    s_add_u32 s93, s93, 40960
    s_cmp_lt_u32 s5, 24
    s_cbranch_scc1 L_vp
    s_add_u32 s30, s28, 256
    s_add_u32 s28, s20, s28
    s_addc_u32 s29, s21, 0
    s_add_u32 s30, s20, s30
    s_addc_u32 s31, s21, 0
    s_mov_b32 s36, 0
L_sp:
    s_load_dwordx2 s[8:9], s[28:29], 0 glc
    s_load_dwordx2 s[10:11], s[28:29], 512 glc
    s_load_dwordx2 s[12:13], s[28:29], 1024 glc
    s_load_dwordx2 s[14:15], s[30:31], 0 glc
    s_load_dwordx2 s[40:41], s[30:31], 512 glc
    s_load_dwordx2 s[42:43], s[30:31], 1024 glc
    s_add_u32 s36, s36, 1
    s_cmp_gt_u32 s36, 1000000
    s_waitcnt lgkmcnt(0)
    s_cbranch_scc1 L_spa_x
    s_cmp_eq_u64 s[8:9], s[56:57]
    s_cbranch_scc0 L_sp
    s_cmp_eq_u64 s[10:11], s[56:57]
    s_cbranch_scc0 L_sp
    s_cmp_eq_u64 s[12:13], s[56:57]
    s_cbranch_scc0 L_sp
    s_cmp_eq_u64 s[14:15], s[56:57]
    s_cbranch_scc0 L_sp
    s_cmp_eq_u64 s[40:41], s[56:57]
    s_cbranch_scc0 L_sp
    s_cmp_eq_u64 s[42:43], s[56:57]
    s_cbranch_scc0 L_sp
    s_branch L_spa_x
L_vp:
    s_waitcnt vmcnt(4)
    v_cmp_ne_u64 vcc, s[56:57], v[4:5]
    s_cbranch_vccz L_spa_x
    s_mov_b32 s36, 0
L_spa:
    s_sleep 12
    buffer_load_dwordx2 v[4:5], v62, s[20:23], 0 offen sc1
    s_add_u32 s36, s36, 1
    s_cmp_gt_u32 s36, 1000000
    s_waitcnt vmcnt(0)
    s_cbranch_scc1 L_spa_x
    v_cmp_ne_u64 vcc, s[56:57], v[4:5]
    s_cbranch_vccnz L_spa
L_spa_x:
    buffer_load_dwordx4 v[8:11], v0, s[20:23], s95 offen offset:0 sc1
    buffer_load_dwordx4 v[12:15], v0, s[20:23], s95 offen offset:1024 sc1
    buffer_load_dwordx4 v[16:19], v0, s[20:23], s95 offen offset:2048 sc1
    buffer_load_dwordx4 v[20:23], v0, s[20:23], s95 offen offset:3072 sc1
    s_add_u32 s95, s82, s89
    buffer_load_dwordx2 v[4:5], v3, s[20:23], s96 offen sc1
    buffer_load_dwordx4 v[24:27], v0, s[20:23], s95 offen offset:0 sc1
    buffer_load_dwordx4 v[28:31], v0, s[20:23], s95 offen offset:1024 sc1
    s_waitcnt vmcnt(11)
    ds_read_b64_tr_b16 v[96:97], v56 offset:34816
    ds_read_b64_tr_b16 v[98:99], v56 offset:36864
    ds_read_b64_tr_b16 v[100:101], v57 offset:34816
    ds_read_b64_tr_b16 v[102:103], v57 offset:36864
    ds_read_b64_tr_b16 v[104:105], v58 offset:34816
    ds_read_b64_tr_b16 v[106:107], v58 offset:36864
    ds_read_b64_tr_b16 v[108:109], v59 offset:34816
    ds_read_b64_tr_b16 v[110:111], v59 offset:36864
    s_waitcnt vmcnt(7)
    ds_read_b64_tr_b16 v[112:113], v56 offset:52224
    ds_read_b64_tr_b16 v[114:115], v56 offset:54272
    ds_read_b64_tr_b16 v[116:117], v57 offset:52224
    ds_read_b64_tr_b16 v[118:119], v57 offset:54272
    ds_read_b64_tr_b16 v[120:121], v58 offset:52224
    ds_read_b64_tr_b16 v[122:123], v58 offset:54272
    ds_read_b64_tr_b16 v[124:125], v59 offset:52224
    ds_read_b64_tr_b16 v[126:127], v59 offset:54272
    s_cmp_ge_u32 s5, 24
    s_cbranch_scc1 L_cd_x
    v_mov_b32 v62, 156672
    s_mov_b32 s33, 0
L_cd:
    ds_read_b32 v63, v62
    s_add_u32 s33, s33, 1
    s_cmp_gt_u32 s33, 8000000
    s_waitcnt lgkmcnt(0)
    s_cbranch_scc1 L_cd_x
    v_cmp_gt_u32 vcc, 4, v63
    s_cbranch_vccnz L_cd
L_cd_x:
    s_mov_b32 s33, 1
    s_setprio 1
    s_waitcnt lgkmcnt(0)
    s_mov_b32 s98, 0x7f000000
    s_mov_b64 s[38:39], -1
    .p2align 3
L_p2:
    v_mfma_f32_16x16x32_bf16 v[56:59], v[120:123], v[36:39], v[48:51]
    s_waitcnt vmcnt(6)
    v_mfma_f32_16x16x32_bf16 v[60:63], v[124:127], v[36:39], v[52:55]
    ds_write_b128 v6, v[40:43] offset:0
    v_mfma_f32_16x16x32_bf16 v[48:51], a[8:11], v[8:11], 0
    buffer_load_dwordx4 v[32:35], v0, s[20:23], s95 offen offset:2048 sc1
    v_mfma_f32_16x16x32_bf16 v[52:55], a[12:15], v[8:11], 0
    ds_write_b128 v6, v[44:47] offset:64
    s_waitcnt vmcnt(6)
    v_mfma_f32_16x16x32_bf16 v[40:43], a[0:3], v[8:11], 0
    s_lshr_b32 s83, s83, 3
    s_and_b32 s0, s83, 7
    v_mfma_f32_16x16x32_bf16 v[40:43], a[16:19], v[12:15], v[40:43]
    buffer_load_dwordx4 v[36:39], v0, s[20:23], s95 offen offset:3072 sc1
    s_add_u32 s95, s82, s90
    v_mfma_f32_16x16x32_bf16 v[44:47], a[4:7], v[8:11], 0
    s_add_u32 s0, s0, s58
    s_lshr_b32 s35, s0, 4
    v_mfma_f32_16x16x32_bf16 v[44:47], a[20:23], v[12:15], v[44:47]
    s_lshr_b32 s35, s63, s35
    s_waitcnt vmcnt(6)
    v_mfma_f32_16x16x32_bf16 v[48:51], a[24:27], v[12:15], v[48:51]
    s_and_b32 s35, s35, 8192
    s_and_b32 s82, s0, 63
    v_mfma_f32_16x16x32_bf16 v[48:51], a[40:43], v[16:19], v[48:51]
    buffer_load_dwordx4 v[8:11], v0, s[20:23], s95 offen offset:0 sc1
    s_lshl_b32 s82, s82, 17
    v_mfma_f32_16x16x32_bf16 v[52:55], a[44:47], v[16:19], v[52:55]
    s_or_b32 s82, s82, s35
    s_lshl_b32 s34, s0, 7
    v_mfma_f32_16x16x32_bf16 v[52:55], a[28:31], v[12:15], v[52:55]
    s_cmp_ge_u32 s33, s59
    s_waitcnt vmcnt(6)
    v_mfma_f32_16x16x32_bf16 v[40:43], a[32:35], v[16:19], v[40:43]
    ds_write_b128 v6, v[56:59] offset:128
    v_mfma_f32_16x16x32_bf16 v[40:43], a[48:51], v[20:23], v[40:43]
    buffer_load_dwordx4 v[12:15], v0, s[20:23], s95 offen offset:1024 sc1
    s_cselect_b32 s82, s98, s82
    v_mfma_f32_16x16x32_bf16 v[44:47], a[52:55], v[20:23], v[44:47]
    v_mfma_f32_16x16x32_bf16 v[44:47], a[36:39], v[16:19], v[44:47]
    s_waitcnt vmcnt(5)
    v_mfma_f32_16x16x32_bf16 v[48:51], a[56:59], v[20:23], v[48:51]
    ds_write_b128 v6, v[60:63] offset:192
    v_mfma_f32_16x16x32_bf16 v[48:51], a[72:75], v[24:27], v[48:51]
    buffer_load_dwordx4 v[16:19], v0, s[20:23], s95 offen offset:2048 sc1
    v_mfma_f32_16x16x32_bf16 v[52:55], a[76:79], v[24:27], v[52:55]
    v_add_u32 v6, s91, v6
    v_mfma_f32_16x16x32_bf16 v[52:55], a[60:63], v[20:23], v[52:55]
    ds_write_b32 v7, v6
    s_waitcnt vmcnt(5)
    v_mfma_f32_16x16x32_bf16 v[40:43], a[64:67], v[24:27], v[40:43]
    v_cmp_ne_u64 vcc, s[56:57], v[4:5]
    s_andn2_b32 s34, s96, s34
    v_mfma_f32_16x16x32_bf16 v[40:43], a[80:83], v[28:31], v[40:43]
    buffer_load_dwordx4 v[20:23], v0, s[20:23], s95 offen offset:3072 sc1
    s_cselect_b64 s[34:35], 0, -1
    v_mfma_f32_16x16x32_bf16 v[44:47], a[84:87], v[28:31], v[44:47]
    s_and_b64 s[34:35], s[34:35], vcc
    s_cbranch_scc1 L_spb0
    L_spb0_r:
    v_mfma_f32_16x16x32_bf16 v[44:47], a[68:71], v[24:27], v[44:47]
    s_add_u32 s95, s82, s88
    s_waitcnt vmcnt(5)
    v_mfma_f32_16x16x32_bf16 v[48:51], a[88:91], v[28:31], v[48:51]
    s_movk_i32 s96, 256
    s_mov_b32 s91, 17408
    v_mfma_f32_16x16x32_bf16 v[48:51], a[104:107], v[32:35], v[48:51]
    buffer_load_dwordx4 v[24:27], v0, s[20:23], s95 offen offset:0 sc1
    v_mfma_f32_16x16x32_bf16 v[52:55], a[108:111], v[32:35], v[52:55]
    s_or_b64 vcc, vcc, s[38:39]
    s_mov_b64 s[38:39], 0
    v_mfma_f32_16x16x32_bf16 v[52:55], a[92:95], v[28:31], v[52:55]
    s_waitcnt vmcnt(5)
    v_mfma_f32_16x16x32_bf16 v[40:43], a[96:99], v[32:35], v[40:43]
    v_mfma_f32_16x16x32_bf16 v[40:43], a[112:115], v[36:39], v[40:43]
    buffer_load_dwordx4 v[28:31], v0, s[20:23], s95 offen offset:1024 sc1
    v_mfma_f32_16x16x32_bf16 v[44:47], a[116:119], v[36:39], v[44:47]
    v_mfma_f32_16x16x32_bf16 v[44:47], a[100:103], v[32:35], v[44:47]
    s_waitcnt vmcnt(5)
    v_mfma_f32_16x16x32_bf16 v[48:51], a[120:123], v[36:39], v[48:51]
    v_mfma_f32_16x16x32_bf16 v[48:51], v[72:75], v[8:11], v[48:51]
    buffer_load_dwordx4 v[32:35], v0, s[20:23], s95 offen offset:2048 sc1
    v_mfma_f32_16x16x32_bf16 v[52:55], v[76:79], v[8:11], v[52:55]
    v_mfma_f32_16x16x32_bf16 v[52:55], a[124:127], v[36:39], v[52:55]
    s_waitcnt vmcnt(5)
    v_mfma_f32_16x16x32_bf16 v[40:43], v[64:67], v[8:11], v[40:43]
    v_mfma_f32_16x16x32_bf16 v[40:43], v[80:83], v[12:15], v[40:43]
    buffer_load_dwordx4 v[36:39], v0, s[20:23], s95 offen offset:3072 sc1
    s_add_u32 s95, s82, s89
    v_mfma_f32_16x16x32_bf16 v[44:47], v[84:87], v[12:15], v[44:47]
    s_mov_b64 exec, vcc
    buffer_load_dwordx2 v[4:5], v3, s[20:23], s96 offen sc1
    s_mov_b64 exec, -1
    v_mfma_f32_16x16x32_bf16 v[44:47], v[68:71], v[8:11], v[44:47]
    s_waitcnt vmcnt(6)
    v_mfma_f32_16x16x32_bf16 v[48:51], v[88:91], v[12:15], v[48:51]
    v_mfma_f32_16x16x32_bf16 v[48:51], v[104:107], v[16:19], v[48:51]
    buffer_load_dwordx4 v[8:11], v0, s[20:23], s95 offen offset:0 sc1
    v_mfma_f32_16x16x32_bf16 v[52:55], v[108:111], v[16:19], v[52:55]
    v_mfma_f32_16x16x32_bf16 v[52:55], v[92:95], v[12:15], v[52:55]
    s_waitcnt vmcnt(6)
    v_mfma_f32_16x16x32_bf16 v[40:43], v[96:99], v[16:19], v[40:43]
    v_mfma_f32_16x16x32_bf16 v[40:43], v[112:115], v[20:23], v[40:43]
    buffer_load_dwordx4 v[12:15], v0, s[20:23], s95 offen offset:1024 sc1
    v_mfma_f32_16x16x32_bf16 v[44:47], v[100:103], v[16:19], v[44:47]
    s_add_u32 s33, s33, 1
    s_cmp_le_u32 s33, s59
    v_mfma_f32_16x16x32_bf16 v[44:47], v[116:119], v[20:23], v[44:47]
    s_cbranch_scc0 L_p2f
    .p2align 3
    v_mfma_f32_16x16x32_bf16 v[56:59], v[120:123], v[20:23], v[48:51]
    s_waitcnt vmcnt(6)
    v_mfma_f32_16x16x32_bf16 v[60:63], v[124:127], v[20:23], v[52:55]
    ds_write_b128 v6, v[40:43] offset:0
    v_mfma_f32_16x16x32_bf16 v[48:51], a[8:11], v[24:27], 0
    buffer_load_dwordx4 v[16:19], v0, s[20:23], s95 offen offset:2048 sc1
    v_mfma_f32_16x16x32_bf16 v[52:55], a[12:15], v[24:27], 0
    ds_write_b128 v6, v[44:47] offset:64
    s_waitcnt vmcnt(6)
    v_mfma_f32_16x16x32_bf16 v[40:43], a[0:3], v[24:27], 0
    s_lshr_b32 s83, s83, 3
    s_and_b32 s0, s83, 7
    v_mfma_f32_16x16x32_bf16 v[40:43], a[16:19], v[28:31], v[40:43]
    buffer_load_dwordx4 v[20:23], v0, s[20:23], s95 offen offset:3072 sc1
    s_add_u32 s95, s82, s90
    v_mfma_f32_16x16x32_bf16 v[44:47], a[4:7], v[24:27], 0
    s_add_u32 s0, s0, s58
    s_lshr_b32 s35, s0, 4
    v_mfma_f32_16x16x32_bf16 v[44:47], a[20:23], v[28:31], v[44:47]
    s_lshr_b32 s35, s63, s35
    s_waitcnt vmcnt(6)
    v_mfma_f32_16x16x32_bf16 v[48:51], a[24:27], v[28:31], v[48:51]
    s_and_b32 s35, s35, 8192
    s_and_b32 s82, s0, 63
    v_mfma_f32_16x16x32_bf16 v[48:51], a[40:43], v[32:35], v[48:51]
    buffer_load_dwordx4 v[24:27], v0, s[20:23], s95 offen offset:0 sc1
    s_lshl_b32 s82, s82, 17
    v_mfma_f32_16x16x32_bf16 v[52:55], a[44:47], v[32:35], v[52:55]
    s_or_b32 s82, s82, s35
    s_lshl_b32 s34, s0, 7
    v_mfma_f32_16x16x32_bf16 v[52:55], a[28:31], v[28:31], v[52:55]
    s_cmp_ge_u32 s33, s59
    s_waitcnt vmcnt(6)
    v_mfma_f32_16x16x32_bf16 v[40:43], a[32:35], v[32:35], v[40:43]
    ds_write_b128 v6, v[56:59] offset:128
    v_mfma_f32_16x16x32_bf16 v[40:43], a[48:51], v[36:39], v[40:43]
    buffer_load_dwordx4 v[28:31], v0, s[20:23], s95 offen offset:1024 sc1
    s_cselect_b32 s82, s98, s82
    v_mfma_f32_16x16x32_bf16 v[44:47], a[52:55], v[36:39], v[44:47]
    v_mfma_f32_16x16x32_bf16 v[44:47], a[36:39], v[32:35], v[44:47]
    s_waitcnt vmcnt(5)
    v_mfma_f32_16x16x32_bf16 v[48:51], a[56:59], v[36:39], v[48:51]
    ds_write_b128 v6, v[60:63] offset:192
    v_mfma_f32_16x16x32_bf16 v[48:51], a[72:75], v[8:11], v[48:51]
    buffer_load_dwordx4 v[32:35], v0, s[20:23], s95 offen offset:2048 sc1
    v_mfma_f32_16x16x32_bf16 v[52:55], a[76:79], v[8:11], v[52:55]
    v_add_u32 v6, s91, v6
    v_mfma_f32_16x16x32_bf16 v[52:55], a[60:63], v[36:39], v[52:55]
    ds_write_b32 v7, v6
    s_waitcnt vmcnt(5)
    v_mfma_f32_16x16x32_bf16 v[40:43], a[64:67], v[8:11], v[40:43]
    v_cmp_ne_u64 vcc, s[56:57], v[4:5]
    s_andn2_b32 s34, s96, s34
    v_mfma_f32_16x16x32_bf16 v[40:43], a[80:83], v[12:15], v[40:43]
    buffer_load_dwordx4 v[36:39], v0, s[20:23], s95 offen offset:3072 sc1
    s_cselect_b64 s[34:35], 0, -1
    v_mfma_f32_16x16x32_bf16 v[44:47], a[84:87], v[12:15], v[44:47]
    s_and_b64 s[34:35], s[34:35], vcc
    s_cbranch_scc1 L_spb4
    L_spb4_r:
    v_mfma_f32_16x16x32_bf16 v[44:47], a[68:71], v[8:11], v[44:47]
    s_add_u32 s95, s82, s88
    s_waitcnt vmcnt(5)
    v_mfma_f32_16x16x32_bf16 v[48:51], a[88:91], v[12:15], v[48:51]
    s_movk_i32 s96, 256
    s_mov_b32 s91, 17408
    v_mfma_f32_16x16x32_bf16 v[48:51], a[104:107], v[16:19], v[48:51]
    buffer_load_dwordx4 v[8:11], v0, s[20:23], s95 offen offset:0 sc1
    v_mfma_f32_16x16x32_bf16 v[52:55], a[108:111], v[16:19], v[52:55]
    s_or_b64 vcc, vcc, s[38:39]
    s_mov_b64 s[38:39], 0
    v_mfma_f32_16x16x32_bf16 v[52:55], a[92:95], v[12:15], v[52:55]
    s_waitcnt vmcnt(5)
    v_mfma_f32_16x16x32_bf16 v[40:43], a[96:99], v[16:19], v[40:43]
    v_mfma_f32_16x16x32_bf16 v[40:43], a[112:115], v[20:23], v[40:43]
    buffer_load_dwordx4 v[12:15], v0, s[20:23], s95 offen offset:1024 sc1
    v_mfma_f32_16x16x32_bf16 v[44:47], a[116:119], v[20:23], v[44:47]
    v_mfma_f32_16x16x32_bf16 v[44:47], a[100:103], v[16:19], v[44:47]
    s_waitcnt vmcnt(5)
    v_mfma_f32_16x16x32_bf16 v[48:51], a[120:123], v[20:23], v[48:51]
    v_mfma_f32_16x16x32_bf16 v[48:51], v[72:75], v[24:27], v[48:51]
    buffer_load_dwordx4 v[16:19], v0, s[20:23], s95 offen offset:2048 sc1
    v_mfma_f32_16x16x32_bf16 v[52:55], v[76:79], v[24:27], v[52:55]
    v_mfma_f32_16x16x32_bf16 v[52:55], a[124:127], v[20:23], v[52:55]
    s_waitcnt vmcnt(5)
    v_mfma_f32_16x16x32_bf16 v[40:43], v[64:67], v[24:27], v[40:43]
    v_mfma_f32_16x16x32_bf16 v[40:43], v[80:83], v[28:31], v[40:43]
    buffer_load_dwordx4 v[20:23], v0, s[20:23], s95 offen offset:3072 sc1
    s_add_u32 s95, s82, s89
    v_mfma_f32_16x16x32_bf16 v[44:47], v[84:87], v[28:31], v[44:47]
    s_mov_b64 exec, vcc
    buffer_load_dwordx2 v[4:5], v3, s[20:23], s96 offen sc1
    s_mov_b64 exec, -1
    v_mfma_f32_16x16x32_bf16 v[44:47], v[68:71], v[24:27], v[44:47]
    s_waitcnt vmcnt(6)
    v_mfma_f32_16x16x32_bf16 v[48:51], v[88:91], v[28:31], v[48:51]
    v_mfma_f32_16x16x32_bf16 v[48:51], v[104:107], v[32:35], v[48:51]
    buffer_load_dwordx4 v[24:27], v0, s[20:23], s95 offen offset:0 sc1
    v_mfma_f32_16x16x32_bf16 v[52:55], v[108:111], v[32:35], v[52:55]
    v_mfma_f32_16x16x32_bf16 v[52:55], v[92:95], v[28:31], v[52:55]
    s_waitcnt vmcnt(6)
    v_mfma_f32_16x16x32_bf16 v[40:43], v[96:99], v[32:35], v[40:43]
    v_mfma_f32_16x16x32_bf16 v[40:43], v[112:115], v[36:39], v[40:43]
    buffer_load_dwordx4 v[28:31], v0, s[20:23], s95 offen offset:1024 sc1
    v_mfma_f32_16x16x32_bf16 v[44:47], v[100:103], v[32:35], v[44:47]
    s_add_u32 s33, s33, 1
    s_cmp_le_u32 s33, s59
    v_mfma_f32_16x16x32_bf16 v[44:47], v[116:119], v[36:39], v[44:47]
    s_cbranch_scc1 L_p2
    v_mfma_f32_16x16x32_bf16 v[56:59], v[120:123], v[36:39], v[48:51]
    v_mfma_f32_16x16x32_bf16 v[60:63], v[124:127], v[36:39], v[52:55]
    s_branch L_p2e
L_p2f:
    v_mfma_f32_16x16x32_bf16 v[56:59], v[120:123], v[20:23], v[48:51]
    v_mfma_f32_16x16x32_bf16 v[60:63], v[124:127], v[20:23], v[52:55]
    s_nop 0
L_p2e:
    s_nop 2
    ds_write_b128 v6, v[40:43] offset:0
    s_nop 0
    ds_write_b128 v6, v[44:47] offset:64
    s_nop 0
    ds_write_b128 v6, v[56:59] offset:128
    ds_write_b128 v6, v[60:63] offset:192
    v_add_u32 v6, s91, v6
    ds_write_b32 v7, v6
    s_endpgm
L_spb0:
    s_mov_b32 s36, 0
L_spb0l:
    s_sleep 12
    buffer_load_dwordx2 v[4:5], v3, s[20:23], s96 offen sc1
    s_add_u32 s36, s36, 1
    s_cmp_gt_u32 s36, 1000000
    s_waitcnt vmcnt(0)
    s_cbranch_scc1 L_spb0l_x
    v_cmp_ne_u64 vcc, s[56:57], v[4:5]
    s_cbranch_vccnz L_spb0l
L_spb0l_x:
    s_branch L_spb0_r
L_spb4:
    s_mov_b32 s36, 0
L_spb4l:
    s_sleep 12
    buffer_load_dwordx2 v[4:5], v3, s[20:23], s96 offen sc1
    s_add_u32 s36, s36, 1
    s_cmp_gt_u32 s36, 1000000
    s_waitcnt vmcnt(0)
    s_cbranch_scc1 L_spb4l_x
    v_cmp_ne_u64 vcc, s[56:57], v[4:5]
    s_cbranch_vccnz L_spb4l
L_spb4l_x:
    s_branch L_spb4_r
    .p2align 12
L_c2:
    s_barrier
    ds_read_b64_tr_b16 a[0:1], v18 offset:0
    ds_read_b64_tr_b16 a[2:3], v18 offset:512
    ds_read_b128 a[64:67], v16 offset:0
    ds_read_b64_tr_b16 a[16:17], v18 offset:4096
    ds_read_b64_tr_b16 a[18:19], v18 offset:4608
    ds_read_b128 a[72:75], v17 offset:0
    ds_read_b128 a[76:79], v17 offset:2048
    ds_read_b128 a[68:71], v16 offset:2048
    ds_read_b64_tr_b16 a[4:5], v19 offset:0
    ds_read_b64_tr_b16 a[6:7], v19 offset:512
    ds_read_b64_tr_b16 a[20:21], v19 offset:4096
    ds_read_b64_tr_b16 a[22:23], v19 offset:4608
    ds_read_b64_tr_b16 a[8:9], v20 offset:0
    ds_read_b64_tr_b16 a[10:11], v20 offset:512
    ds_read_b64_tr_b16 a[24:25], v20 offset:4096
    ds_read_b64_tr_b16 a[26:27], v20 offset:4608
    s_branch L_p1m
    .p2align 3
    s_nop 0
L_p1b:
    s_barrier
    v_mfma_f32_16x16x32_bf16 v[64:67], a[32:35], a[80:83], v[64:67]
    ds_read_b64_tr_b16 a[0:1], v18 offset:0
    ds_read_b64_tr_b16 a[2:3], v18 offset:512
    v_mfma_f32_16x16x32_bf16 v[64:67], a[48:51], a[88:91], v[64:67]
    ds_read_b128 a[64:67], v16 offset:0
    v_mfma_f32_16x16x32_bf16 v[80:83], a[48:51], a[92:95], v[80:83]
    ds_read_b64_tr_b16 a[16:17], v18 offset:4096
    ds_read_b64_tr_b16 a[18:19], v18 offset:4608
    v_mfma_f32_16x16x32_bf16 v[80:83], a[32:35], a[84:87], v[80:83]
    ds_read_b128 a[72:75], v17 offset:0
    v_mfma_f32_16x16x32_bf16 v[84:87], a[36:39], a[84:87], v[84:87]
    ds_read_b128 a[76:79], v17 offset:2048
    v_mfma_f32_16x16x32_bf16 v[84:87], a[52:55], a[92:95], v[84:87]
    ds_read_b128 a[68:71], v16 offset:2048
    v_mfma_f32_16x16x32_bf16 v[68:71], a[52:55], a[88:91], v[68:71]
    ds_read_b64_tr_b16 a[4:5], v19 offset:0
    ds_read_b64_tr_b16 a[6:7], v19 offset:512
    v_mfma_f32_16x16x32_bf16 v[68:71], a[36:39], a[80:83], v[68:71]
    ds_read_b64_tr_b16 a[20:21], v19 offset:4096
    ds_read_b64_tr_b16 a[22:23], v19 offset:4608
    v_mfma_f32_16x16x32_bf16 v[72:75], a[40:43], a[80:83], v[72:75]
    ds_read_b64_tr_b16 a[8:9], v20 offset:0
    ds_read_b64_tr_b16 a[10:11], v20 offset:512
    v_mfma_f32_16x16x32_bf16 v[72:75], a[56:59], a[88:91], v[72:75]
    ds_read_b64_tr_b16 a[24:25], v20 offset:4096
    ds_read_b64_tr_b16 a[26:27], v20 offset:4608
    v_mfma_f32_16x16x32_bf16 v[88:91], a[56:59], a[92:95], v[88:91]
    v_mfma_f32_16x16x32_bf16 v[88:91], a[40:43], a[84:87], v[88:91]
    v_mfma_f32_16x16x32_bf16 v[92:95], a[44:47], a[84:87], v[92:95]
    v_mfma_f32_16x16x32_bf16 v[92:95], a[60:63], a[92:95], v[92:95]
    v_mfma_f32_16x16x32_bf16 v[76:79], a[60:63], a[88:91], v[76:79]
    v_mfma_f32_16x16x32_bf16 v[76:79], a[44:47], a[80:83], v[76:79]
L_p1m:
    s_waitcnt lgkmcnt(4)
    v_mfma_f32_16x16x32_bf16 v[32:35], a[0:3], a[64:67], v[32:35]
    ds_read_b64_tr_b16 a[12:13], v21 offset:0
    ds_read_b64_tr_b16 a[14:15], v21 offset:512
    v_mfma_f32_16x16x32_bf16 v[32:35], a[16:19], a[72:75], v[32:35]
    ds_read_b64_tr_b16 a[28:29], v21 offset:4096
    ds_read_b64_tr_b16 a[30:31], v21 offset:4608
    v_mfma_f32_16x16x32_bf16 v[48:51], a[16:19], a[76:79], v[48:51]
    ds_read_b128 a[80:83], v16 offset:4096
    v_mfma_f32_16x16x32_bf16 v[48:51], a[0:3], a[68:71], v[48:51]
    ds_read_b128 a[88:91], v17 offset:4096
    v_mfma_f32_16x16x32_bf16 v[52:55], a[4:7], a[68:71], v[52:55]
    ds_read_b128 a[92:95], v17 offset:6144
    v_mfma_f32_16x16x32_bf16 v[52:55], a[20:23], a[76:79], v[52:55]
    ds_read_b128 a[84:87], v16 offset:6144
    v_mfma_f32_16x16x32_bf16 v[36:39], a[20:23], a[72:75], v[36:39]
    s_add_u32 s37, s37, 32768
    s_cmp_ge_u32 s37, 98304
    v_mfma_f32_16x16x32_bf16 v[36:39], a[4:7], a[64:67], v[36:39]
    s_cselect_b32 s32, s100, 32768
    s_waitcnt lgkmcnt(8)
    v_mfma_f32_16x16x32_bf16 v[40:43], a[8:11], a[64:67], v[40:43]
    s_cselect_b32 s37, 0, s37
    v_add_u32 v18, s32, v18
    v_mfma_f32_16x16x32_bf16 v[40:43], a[24:27], a[72:75], v[40:43]
    v_add_u32 v19, s32, v19
    v_add_u32 v20, s32, v20
    v_mfma_f32_16x16x32_bf16 v[56:59], a[24:27], a[76:79], v[56:59]
    v_add_u32 v21, s32, v21
    v_add_u32 v16, s32, v16
    v_mfma_f32_16x16x32_bf16 v[56:59], a[8:11], a[68:71], v[56:59]
    v_add_u32 v17, s32, v17
    s_waitcnt lgkmcnt(4)
    v_mfma_f32_16x16x32_bf16 v[60:63], a[12:15], a[68:71], v[60:63]
    v_mfma_f32_16x16x32_bf16 v[60:63], a[28:31], a[76:79], v[60:63]
    v_mfma_f32_16x16x32_bf16 v[44:47], a[28:31], a[72:75], v[44:47]
    v_mfma_f32_16x16x32_bf16 v[44:47], a[12:15], a[64:67], v[44:47]
    s_waitcnt lgkmcnt(0)
    s_barrier
    v_mfma_f32_16x16x32_bf16 v[64:67], a[0:3], a[80:83], v[64:67]
    ds_read_b64_tr_b16 a[32:33], v18 offset:0
    ds_read_b64_tr_b16 a[34:35], v18 offset:512
    v_mfma_f32_16x16x32_bf16 v[64:67], a[16:19], a[88:91], v[64:67]
    ds_read_b128 a[64:67], v16 offset:0
    v_mfma_f32_16x16x32_bf16 v[80:83], a[16:19], a[92:95], v[80:83]
    ds_read_b64_tr_b16 a[48:49], v18 offset:4096
    ds_read_b64_tr_b16 a[50:51], v18 offset:4608
    v_mfma_f32_16x16x32_bf16 v[80:83], a[0:3], a[84:87], v[80:83]
    ds_read_b128 a[72:75], v17 offset:0
    v_mfma_f32_16x16x32_bf16 v[84:87], a[4:7], a[84:87], v[84:87]
    ds_read_b128 a[76:79], v17 offset:2048
    v_mfma_f32_16x16x32_bf16 v[84:87], a[20:23], a[92:95], v[84:87]
    ds_read_b128 a[68:71], v16 offset:2048
    v_mfma_f32_16x16x32_bf16 v[68:71], a[20:23], a[88:91], v[68:71]
    ds_read_b64_tr_b16 a[36:37], v19 offset:0
    ds_read_b64_tr_b16 a[38:39], v19 offset:512
    v_mfma_f32_16x16x32_bf16 v[68:71], a[4:7], a[80:83], v[68:71]
    ds_read_b64_tr_b16 a[52:53], v19 offset:4096
    ds_read_b64_tr_b16 a[54:55], v19 offset:4608
    v_mfma_f32_16x16x32_bf16 v[72:75], a[8:11], a[80:83], v[72:75]
    ds_read_b64_tr_b16 a[40:41], v20 offset:0
    ds_read_b64_tr_b16 a[42:43], v20 offset:512
    v_mfma_f32_16x16x32_bf16 v[72:75], a[24:27], a[88:91], v[72:75]
    ds_read_b64_tr_b16 a[56:57], v20 offset:4096
    ds_read_b64_tr_b16 a[58:59], v20 offset:4608
    v_mfma_f32_16x16x32_bf16 v[88:91], a[24:27], a[92:95], v[88:91]
    v_mfma_f32_16x16x32_bf16 v[88:91], a[8:11], a[84:87], v[88:91]
    v_mfma_f32_16x16x32_bf16 v[92:95], a[12:15], a[84:87], v[92:95]
    v_mfma_f32_16x16x32_bf16 v[92:95], a[28:31], a[92:95], v[92:95]
    v_mfma_f32_16x16x32_bf16 v[76:79], a[28:31], a[88:91], v[76:79]
    v_mfma_f32_16x16x32_bf16 v[76:79], a[12:15], a[80:83], v[76:79]
    s_waitcnt lgkmcnt(4)
    v_mfma_f32_16x16x32_bf16 v[32:35], a[32:35], a[64:67], v[32:35]
    ds_read_b64_tr_b16 a[44:45], v21 offset:0
    ds_read_b64_tr_b16 a[46:47], v21 offset:512
    v_mfma_f32_16x16x32_bf16 v[32:35], a[48:51], a[72:75], v[32:35]
    ds_read_b64_tr_b16 a[60:61], v21 offset:4096
    ds_read_b64_tr_b16 a[62:63], v21 offset:4608
    v_mfma_f32_16x16x32_bf16 v[48:51], a[48:51], a[76:79], v[48:51]
    ds_read_b128 a[80:83], v16 offset:4096
    v_mfma_f32_16x16x32_bf16 v[48:51], a[32:35], a[68:71], v[48:51]
    ds_read_b128 a[88:91], v17 offset:4096
    v_mfma_f32_16x16x32_bf16 v[52:55], a[36:39], a[68:71], v[52:55]
    ds_read_b128 a[92:95], v17 offset:6144
    v_mfma_f32_16x16x32_bf16 v[52:55], a[52:55], a[76:79], v[52:55]
    ds_read_b128 a[84:87], v16 offset:6144
    v_mfma_f32_16x16x32_bf16 v[36:39], a[52:55], a[72:75], v[36:39]
    s_add_u32 s37, s37, 32768
    s_cmp_ge_u32 s37, 98304
    v_mfma_f32_16x16x32_bf16 v[36:39], a[36:39], a[64:67], v[36:39]
    s_cselect_b32 s32, s100, 32768
    s_waitcnt lgkmcnt(8)
    v_mfma_f32_16x16x32_bf16 v[40:43], a[40:43], a[64:67], v[40:43]
    s_cselect_b32 s37, 0, s37
    v_add_u32 v18, s32, v18
    v_mfma_f32_16x16x32_bf16 v[40:43], a[56:59], a[72:75], v[40:43]
    v_add_u32 v19, s32, v19
    v_add_u32 v20, s32, v20
    v_mfma_f32_16x16x32_bf16 v[56:59], a[56:59], a[76:79], v[56:59]
    v_add_u32 v21, s32, v21
    v_add_u32 v16, s32, v16
    v_mfma_f32_16x16x32_bf16 v[56:59], a[40:43], a[68:71], v[56:59]
    v_add_u32 v17, s32, v17
    s_waitcnt lgkmcnt(4)
    v_mfma_f32_16x16x32_bf16 v[60:63], a[44:47], a[68:71], v[60:63]
    s_add_u32 s33, s33, 1
    s_cmp_lt_u32 s33, 5
    v_mfma_f32_16x16x32_bf16 v[60:63], a[60:63], a[76:79], v[60:63]
    v_mfma_f32_16x16x32_bf16 v[44:47], a[60:63], a[72:75], v[44:47]
    v_mfma_f32_16x16x32_bf16 v[44:47], a[44:47], a[64:67], v[44:47]
    s_waitcnt lgkmcnt(0)
    s_cbranch_scc1 L_p1b
    v_mfma_f32_16x16x32_bf16 v[64:67], a[32:35], a[80:83], v[64:67]
    ds_read_b64 v[4:5], v9 offset:8
    v_mfma_f32_16x16x32_bf16 v[64:67], a[48:51], a[88:91], v[64:67]
    v_mul_f32 v96, v32, v32
    v_mul_f32 v97, v33, v33
    v_mfma_f32_16x16x32_bf16 v[80:83], a[48:51], a[92:95], v[80:83]
    v_mul_f32 v98, v34, v34
    v_mul_f32 v99, v35, v35
    v_mfma_f32_16x16x32_bf16 v[80:83], a[32:35], a[84:87], v[80:83]
    v_mul_f32 v100, v36, v36
    v_mul_f32 v101, v37, v37
    v_mfma_f32_16x16x32_bf16 v[84:87], a[36:39], a[84:87], v[84:87]
    v_mul_f32 v102, v38, v38
    v_mul_f32 v103, v39, v39
    v_mfma_f32_16x16x32_bf16 v[84:87], a[52:55], a[92:95], v[84:87]
    v_fma_f32 v96, v96, s38, v22
    v_fma_f32 v97, v97, s38, v22
    v_mfma_f32_16x16x32_bf16 v[68:71], a[52:55], a[88:91], v[68:71]
    v_fma_f32 v98, v98, s38, v22
    v_fma_f32 v99, v99, s38, v22
    v_mfma_f32_16x16x32_bf16 v[68:71], a[36:39], a[80:83], v[68:71]
    v_fma_f32 v100, v100, s38, v22
    v_fma_f32 v101, v101, s38, v22
    v_mfma_f32_16x16x32_bf16 v[72:75], a[40:43], a[80:83], v[72:75]
    v_fma_f32 v102, v102, s38, v22
    v_fma_f32 v103, v103, s38, v22
    v_mfma_f32_16x16x32_bf16 v[72:75], a[56:59], a[88:91], v[72:75]
    v_mul_f32 v96, v96, v32
    v_mul_f32 v97, v97, v33
    v_mfma_f32_16x16x32_bf16 v[88:91], a[56:59], a[92:95], v[88:91]
    v_mul_f32 v98, v98, v34
    v_mul_f32 v99, v99, v35
    v_mfma_f32_16x16x32_bf16 v[88:91], a[40:43], a[84:87], v[88:91]
    v_mul_f32 v100, v100, v36
    v_mul_f32 v101, v101, v37
    v_mfma_f32_16x16x32_bf16 v[92:95], a[44:47], a[84:87], v[92:95]
    v_mul_f32 v102, v102, v38
    v_mul_f32 v103, v103, v39
    v_mfma_f32_16x16x32_bf16 v[92:95], a[60:63], a[92:95], v[92:95]
    s_waitcnt lgkmcnt(0)
    v_readfirstlane_b32 s57, v5
    v_mfma_f32_16x16x32_bf16 v[76:79], a[60:63], a[88:91], v[76:79]
    s_lshr_b32 s34, s6, 1
    v_mfma_f32_16x16x32_bf16 v[76:79], a[44:47], a[80:83], v[76:79]
    .p2align 3
    v_exp_f32 v96, v96
    s_bfe_u32 s63, s57, 0x40018
    v_exp_f32 v97, v97
    s_mul_i32 s63, s63, 17
    v_exp_f32 v98, v98
    s_xor_b32 s63, s63, 15
    v_exp_f32 v99, v99
    s_lshl_b32 s63, s63, 13
    v_exp_f32 v100, v100
    s_lshr_b32 s34, s63, s34
    v_exp_f32 v101, v101
    s_and_b32 s34, s34, 8192
    v_exp_f32 v102, v102
    s_add_u32 s28, s28, s34
    v_exp_f32 v103, v103
    s_add_u32 s29, s29, s34
    v_pk_add_f32 v[96:97], v[96:97], v[24:25]
    v_pk_add_f32 v[98:99], v[98:99], v[24:25]
    v_pk_add_f32 v[100:101], v[100:101], v[24:25]
    v_pk_add_f32 v[102:103], v[102:103], v[24:25]
    v_rcp_f32 v96, v96
    s_add_u32 s93, s93, s34
    v_rcp_f32 v97, v97
    v_rcp_f32 v98, v98
    v_rcp_f32 v99, v99
    v_rcp_f32 v100, v100
    v_rcp_f32 v101, v101
    v_rcp_f32 v102, v102
    v_rcp_f32 v103, v103
    v_pk_mul_f32 v[96:97], v[96:97], v[32:33]
    v_pk_mul_f32 v[98:99], v[98:99], v[34:35]
    v_pk_mul_f32 v[100:101], v[100:101], v[36:37]
    v_pk_mul_f32 v[102:103], v[102:103], v[38:39]
    v_cvt_pk_bf16_f32 v112, v96, v97
    v_cvt_pk_bf16_f32 v113, v98, v99
    v_cvt_pk_bf16_f32 v114, v100, v101
    v_cvt_pk_bf16_f32 v115, v102, v103
    .p2align 3
    buffer_store_dwordx4 v[112:115], v26, s[20:23], s28 offen offset:0 sc1
    v_pk_mul_f32 v[96:97], v[40:41], v[40:41]
    v_pk_mul_f32 v[98:99], v[42:43], v[42:43]
    v_pk_mul_f32 v[100:101], v[44:45], v[44:45]
    v_pk_mul_f32 v[102:103], v[46:47], v[46:47]
    v_pk_fma_f32 v[96:97], v[96:97], s[38:39], v[22:23]
    v_pk_fma_f32 v[98:99], v[98:99], s[38:39], v[22:23]
    v_pk_fma_f32 v[100:101], v[100:101], s[38:39], v[22:23]
    v_pk_fma_f32 v[102:103], v[102:103], s[38:39], v[22:23]
    v_pk_mul_f32 v[96:97], v[96:97], v[40:41]
    v_pk_mul_f32 v[98:99], v[98:99], v[42:43]
    v_pk_mul_f32 v[100:101], v[100:101], v[44:45]
    v_pk_mul_f32 v[102:103], v[102:103], v[46:47]
    v_exp_f32 v96, v96
    v_exp_f32 v97, v97
    v_exp_f32 v98, v98
    v_exp_f32 v99, v99
    v_exp_f32 v100, v100
    v_exp_f32 v101, v101
    v_exp_f32 v102, v102
    v_exp_f32 v103, v103
    v_pk_add_f32 v[96:97], v[96:97], v[24:25]
    v_pk_add_f32 v[98:99], v[98:99], v[24:25]
    v_pk_add_f32 v[100:101], v[100:101], v[24:25]
    v_pk_add_f32 v[102:103], v[102:103], v[24:25]
    v_rcp_f32 v96, v96
    v_rcp_f32 v97, v97
    v_rcp_f32 v98, v98
    v_rcp_f32 v99, v99
    v_rcp_f32 v100, v100
    v_rcp_f32 v101, v101
    v_rcp_f32 v102, v102
    v_rcp_f32 v103, v103
    v_pk_mul_f32 v[96:97], v[96:97], v[40:41]
    v_pk_mul_f32 v[98:99], v[98:99], v[42:43]
    v_pk_mul_f32 v[100:101], v[100:101], v[44:45]
    v_pk_mul_f32 v[102:103], v[102:103], v[46:47]
    v_cvt_pk_bf16_f32 v116, v96, v97
    v_cvt_pk_bf16_f32 v117, v98, v99
    v_cvt_pk_bf16_f32 v118, v100, v101
    v_cvt_pk_bf16_f32 v119, v102, v103
    buffer_store_dwordx4 v[116:119], v26, s[20:23], s28 offen offset:1024 sc1
    s_add_u32 s28, s28, 131072
    v_pk_mul_f32 v[96:97], v[48:49], v[48:49]
    v_pk_mul_f32 v[98:99], v[50:51], v[50:51]
    v_pk_mul_f32 v[100:101], v[52:53], v[52:53]
    v_pk_mul_f32 v[102:103], v[54:55], v[54:55]
    v_pk_fma_f32 v[96:97], v[96:97], s[38:39], v[22:23]
    v_pk_fma_f32 v[98:99], v[98:99], s[38:39], v[22:23]
    v_pk_fma_f32 v[100:101], v[100:101], s[38:39], v[22:23]
    v_pk_fma_f32 v[102:103], v[102:103], s[38:39], v[22:23]
    v_pk_mul_f32 v[96:97], v[96:97], v[48:49]
    v_pk_mul_f32 v[98:99], v[98:99], v[50:51]
    v_pk_mul_f32 v[100:101], v[100:101], v[52:53]
    v_pk_mul_f32 v[102:103], v[102:103], v[54:55]
    v_exp_f32 v96, v96
    v_exp_f32 v97, v97
    v_exp_f32 v98, v98
    v_exp_f32 v99, v99
    v_exp_f32 v100, v100
    v_exp_f32 v101, v101
    v_exp_f32 v102, v102
    v_exp_f32 v103, v103
    v_pk_add_f32 v[96:97], v[96:97], v[24:25]
    v_pk_add_f32 v[98:99], v[98:99], v[24:25]
    v_pk_add_f32 v[100:101], v[100:101], v[24:25]
    v_pk_add_f32 v[102:103], v[102:103], v[24:25]
    v_rcp_f32 v96, v96
    v_rcp_f32 v97, v97
    v_rcp_f32 v98, v98
    v_rcp_f32 v99, v99
    v_rcp_f32 v100, v100
    v_rcp_f32 v101, v101
    v_rcp_f32 v102, v102
    v_rcp_f32 v103, v103
    v_pk_mul_f32 v[96:97], v[96:97], v[48:49]
    v_pk_mul_f32 v[98:99], v[98:99], v[50:51]
    v_pk_mul_f32 v[100:101], v[100:101], v[52:53]
    v_pk_mul_f32 v[102:103], v[102:103], v[54:55]
    v_cvt_pk_bf16_f32 v120, v96, v97
    v_cvt_pk_bf16_f32 v121, v98, v99
    v_cvt_pk_bf16_f32 v122, v100, v101
    v_cvt_pk_bf16_f32 v123, v102, v103
    buffer_store_dwordx4 v[120:123], v26, s[20:23], s28 offen offset:0 sc1
    v_pk_mul_f32 v[96:97], v[56:57], v[56:57]
    v_pk_mul_f32 v[98:99], v[58:59], v[58:59]
    v_pk_mul_f32 v[100:101], v[60:61], v[60:61]
    v_pk_mul_f32 v[102:103], v[62:63], v[62:63]
    v_pk_fma_f32 v[96:97], v[96:97], s[38:39], v[22:23]
    v_pk_fma_f32 v[98:99], v[98:99], s[38:39], v[22:23]
    v_pk_fma_f32 v[100:101], v[100:101], s[38:39], v[22:23]
    v_pk_fma_f32 v[102:103], v[102:103], s[38:39], v[22:23]
    v_pk_mul_f32 v[96:97], v[96:97], v[56:57]
    v_pk_mul_f32 v[98:99], v[98:99], v[58:59]
    v_pk_mul_f32 v[100:101], v[100:101], v[60:61]
    v_pk_mul_f32 v[102:103], v[102:103], v[62:63]
    v_exp_f32 v96, v96
    v_exp_f32 v97, v97
    v_exp_f32 v98, v98
    v_exp_f32 v99, v99
    v_exp_f32 v100, v100
    v_exp_f32 v101, v101
    v_exp_f32 v102, v102
    v_exp_f32 v103, v103
    v_pk_add_f32 v[96:97], v[96:97], v[24:25]
    v_pk_add_f32 v[98:99], v[98:99], v[24:25]
    v_pk_add_f32 v[100:101], v[100:101], v[24:25]
    v_pk_add_f32 v[102:103], v[102:103], v[24:25]
    v_rcp_f32 v96, v96
    v_rcp_f32 v97, v97
    v_rcp_f32 v98, v98
    v_rcp_f32 v99, v99
    v_rcp_f32 v100, v100
    v_rcp_f32 v101, v101
    v_rcp_f32 v102, v102
    v_rcp_f32 v103, v103
    v_pk_mul_f32 v[96:97], v[96:97], v[56:57]
    v_pk_mul_f32 v[98:99], v[98:99], v[58:59]
    v_pk_mul_f32 v[100:101], v[100:101], v[60:61]
    v_pk_mul_f32 v[102:103], v[102:103], v[62:63]
    v_cvt_pk_bf16_f32 v124, v96, v97
    v_cvt_pk_bf16_f32 v125, v98, v99
    v_cvt_pk_bf16_f32 v126, v100, v101
    v_cvt_pk_bf16_f32 v127, v102, v103
    buffer_store_dwordx4 v[124:127], v26, s[20:23], s28 offen offset:1024 sc1
    s_add_u32 s28, s28, 131072
    v_pk_mul_f32 v[96:97], v[64:65], v[64:65]
    v_pk_mul_f32 v[98:99], v[66:67], v[66:67]
    v_pk_mul_f32 v[100:101], v[68:69], v[68:69]
    v_pk_mul_f32 v[102:103], v[70:71], v[70:71]
    v_pk_fma_f32 v[96:97], v[96:97], s[38:39], v[22:23]
    v_pk_fma_f32 v[98:99], v[98:99], s[38:39], v[22:23]
    v_pk_fma_f32 v[100:101], v[100:101], s[38:39], v[22:23]
    v_pk_fma_f32 v[102:103], v[102:103], s[38:39], v[22:23]
    v_pk_mul_f32 v[96:97], v[96:97], v[64:65]
    v_pk_mul_f32 v[98:99], v[98:99], v[66:67]
    v_pk_mul_f32 v[100:101], v[100:101], v[68:69]
    v_pk_mul_f32 v[102:103], v[102:103], v[70:71]
    v_exp_f32 v96, v96
    v_exp_f32 v97, v97
    v_exp_f32 v98, v98
    v_exp_f32 v99, v99
    v_exp_f32 v100, v100
    v_exp_f32 v101, v101
    v_exp_f32 v102, v102
    v_exp_f32 v103, v103
    v_pk_add_f32 v[96:97], v[96:97], v[24:25]
    v_pk_add_f32 v[98:99], v[98:99], v[24:25]
    v_pk_add_f32 v[100:101], v[100:101], v[24:25]
    v_pk_add_f32 v[102:103], v[102:103], v[24:25]
    v_rcp_f32 v96, v96
    v_rcp_f32 v97, v97
    v_rcp_f32 v98, v98
    v_rcp_f32 v99, v99
    v_rcp_f32 v100, v100
    v_rcp_f32 v101, v101
    v_rcp_f32 v102, v102
    v_rcp_f32 v103, v103
    v_pk_mul_f32 v[96:97], v[96:97], v[64:65]
    v_pk_mul_f32 v[98:99], v[98:99], v[66:67]
    v_pk_mul_f32 v[100:101], v[100:101], v[68:69]
    v_pk_mul_f32 v[102:103], v[102:103], v[70:71]
    v_cvt_pk_bf16_f32 v112, v96, v97
    v_cvt_pk_bf16_f32 v113, v98, v99
    v_cvt_pk_bf16_f32 v114, v100, v101
    v_cvt_pk_bf16_f32 v115, v102, v103
    buffer_store_dwordx4 v[112:115], v26, s[20:23], s28 offen offset:0 sc1
    v_pk_mul_f32 v[96:97], v[72:73], v[72:73]
    v_pk_mul_f32 v[98:99], v[74:75], v[74:75]
    v_pk_mul_f32 v[100:101], v[76:77], v[76:77]
    v_pk_mul_f32 v[102:103], v[78:79], v[78:79]
    v_pk_fma_f32 v[96:97], v[96:97], s[38:39], v[22:23]
    v_pk_fma_f32 v[98:99], v[98:99], s[38:39], v[22:23]
    v_pk_fma_f32 v[100:101], v[100:101], s[38:39], v[22:23]
    v_pk_fma_f32 v[102:103], v[102:103], s[38:39], v[22:23]
    v_pk_mul_f32 v[96:97], v[96:97], v[72:73]
    v_pk_mul_f32 v[98:99], v[98:99], v[74:75]
    v_pk_mul_f32 v[100:101], v[100:101], v[76:77]
    v_pk_mul_f32 v[102:103], v[102:103], v[78:79]
    v_exp_f32 v96, v96
    v_exp_f32 v97, v97
    v_exp_f32 v98, v98
    v_exp_f32 v99, v99
    v_exp_f32 v100, v100
    v_exp_f32 v101, v101
    v_exp_f32 v102, v102
    v_exp_f32 v103, v103
    v_pk_add_f32 v[96:97], v[96:97], v[24:25]
    v_pk_add_f32 v[98:99], v[98:99], v[24:25]
    v_pk_add_f32 v[100:101], v[100:101], v[24:25]
    v_pk_add_f32 v[102:103], v[102:103], v[24:25]
    v_rcp_f32 v96, v96
    v_rcp_f32 v97, v97
    v_rcp_f32 v98, v98
    v_rcp_f32 v99, v99
    v_rcp_f32 v100, v100
    v_rcp_f32 v101, v101
    v_rcp_f32 v102, v102
    v_rcp_f32 v103, v103
    v_pk_mul_f32 v[96:97], v[96:97], v[72:73]
    v_pk_mul_f32 v[98:99], v[98:99], v[74:75]
    v_pk_mul_f32 v[100:101], v[100:101], v[76:77]
    v_pk_mul_f32 v[102:103], v[102:103], v[78:79]
    v_cvt_pk_bf16_f32 v116, v96, v97
    v_cvt_pk_bf16_f32 v117, v98, v99
    v_cvt_pk_bf16_f32 v118, v100, v101
    v_cvt_pk_bf16_f32 v119, v102, v103
    buffer_store_dwordx4 v[116:119], v26, s[20:23], s28 offen offset:1024 sc1
    s_add_u32 s28, s28, 131072
    s_waitcnt vmcnt(4)
    s_mov_b64 exec, 0xffff
    buffer_store_dwordx2 v[4:5], v10, s[20:23], s29 offen sc1
    s_mov_b64 exec, -1
    .p2align 3
    v_pk_mul_f32 v[96:97], v[80:81], v[80:81]
    v_pk_mul_f32 v[98:99], v[82:83], v[82:83]
    v_pk_mul_f32 v[100:101], v[84:85], v[84:85]
    v_pk_mul_f32 v[102:103], v[86:87], v[86:87]
    v_pk_fma_f32 v[96:97], v[96:97], s[38:39], v[22:23]
    v_pk_fma_f32 v[98:99], v[98:99], s[38:39], v[22:23]
    v_pk_fma_f32 v[100:101], v[100:101], s[38:39], v[22:23]
    v_pk_fma_f32 v[102:103], v[102:103], s[38:39], v[22:23]
    v_pk_mul_f32 v[96:97], v[96:97], v[80:81]
    v_pk_mul_f32 v[98:99], v[98:99], v[82:83]
    v_pk_mul_f32 v[100:101], v[100:101], v[84:85]
    v_pk_mul_f32 v[102:103], v[102:103], v[86:87]
    v_exp_f32 v96, v96
    v_exp_f32 v97, v97
    v_exp_f32 v98, v98
    v_exp_f32 v99, v99
    v_exp_f32 v100, v100
    v_exp_f32 v101, v101
    v_exp_f32 v102, v102
    v_exp_f32 v103, v103
    v_pk_add_f32 v[96:97], v[96:97], v[24:25]
    v_pk_add_f32 v[98:99], v[98:99], v[24:25]
    v_pk_add_f32 v[100:101], v[100:101], v[24:25]
    v_pk_add_f32 v[102:103], v[102:103], v[24:25]
    v_rcp_f32 v96, v96
    v_rcp_f32 v97, v97
    v_rcp_f32 v98, v98
    v_rcp_f32 v99, v99
    v_rcp_f32 v100, v100
    v_rcp_f32 v101, v101
    v_rcp_f32 v102, v102
    v_rcp_f32 v103, v103
    v_pk_mul_f32 v[96:97], v[96:97], v[80:81]
    v_pk_mul_f32 v[98:99], v[98:99], v[82:83]
    v_pk_mul_f32 v[100:101], v[100:101], v[84:85]
    v_pk_mul_f32 v[102:103], v[102:103], v[86:87]
    v_cvt_pk_bf16_f32 v120, v96, v97
    v_cvt_pk_bf16_f32 v121, v98, v99
    v_cvt_pk_bf16_f32 v122, v100, v101
    v_cvt_pk_bf16_f32 v123, v102, v103
    buffer_store_dwordx4 v[120:123], v26, s[20:23], s28 offen offset:0 sc1
    v_pk_mul_f32 v[96:97], v[88:89], v[88:89]
    v_pk_mul_f32 v[98:99], v[90:91], v[90:91]
    v_pk_mul_f32 v[100:101], v[92:93], v[92:93]
    v_pk_mul_f32 v[102:103], v[94:95], v[94:95]
    v_pk_fma_f32 v[96:97], v[96:97], s[38:39], v[22:23]
    v_pk_fma_f32 v[98:99], v[98:99], s[38:39], v[22:23]
    v_pk_fma_f32 v[100:101], v[100:101], s[38:39], v[22:23]
    v_pk_fma_f32 v[102:103], v[102:103], s[38:39], v[22:23]
    v_pk_mul_f32 v[96:97], v[96:97], v[88:89]
    v_pk_mul_f32 v[98:99], v[98:99], v[90:91]
    v_pk_mul_f32 v[100:101], v[100:101], v[92:93]
    v_pk_mul_f32 v[102:103], v[102:103], v[94:95]
    v_exp_f32 v96, v96
    v_exp_f32 v97, v97
    v_exp_f32 v98, v98
    v_exp_f32 v99, v99
    v_exp_f32 v100, v100
    v_exp_f32 v101, v101
    v_exp_f32 v102, v102
    v_exp_f32 v103, v103
    v_pk_add_f32 v[96:97], v[96:97], v[24:25]
    v_pk_add_f32 v[98:99], v[98:99], v[24:25]
    v_pk_add_f32 v[100:101], v[100:101], v[24:25]
    v_pk_add_f32 v[102:103], v[102:103], v[24:25]
    v_rcp_f32 v96, v96
    v_rcp_f32 v97, v97
    v_rcp_f32 v98, v98
    v_rcp_f32 v99, v99
    v_rcp_f32 v100, v100
    v_rcp_f32 v101, v101
    v_rcp_f32 v102, v102
    v_rcp_f32 v103, v103
    v_pk_mul_f32 v[96:97], v[96:97], v[88:89]
    v_pk_mul_f32 v[98:99], v[98:99], v[90:91]
    v_pk_mul_f32 v[100:101], v[100:101], v[92:93]
    v_pk_mul_f32 v[102:103], v[102:103], v[94:95]
    v_cvt_pk_bf16_f32 v124, v96, v97
    v_cvt_pk_bf16_f32 v125, v98, v99
    v_cvt_pk_bf16_f32 v126, v100, v101
    v_cvt_pk_bf16_f32 v127, v102, v103
    buffer_store_dwordx4 v[124:127], v26, s[20:23], s28 offen offset:1024 sc1
    s_add_u32 s28, s28, 131072
    s_setprio 0
    s_waitcnt vmcnt(5)
    s_mov_b64 exec, 1
    ds_add_rtn_u32 v13, v9, v8 offset:0
    s_waitcnt lgkmcnt(0)
    v_readfirstlane_b32 s35, v13
    s_mov_b64 exec, 0xffff
    s_nop 0
    s_cmp_lg_u32 s35, 3
    s_cbranch_scc1 L_nopub0
    buffer_store_dwordx2 v[4:5], v10, s[20:23], s93 offen offset:0 sc1
L_nopub0:
    s_mov_b64 exec, -1
    s_cmp_lg_u32 s35, 3
    s_cbranch_scc1 L_pw0
    s_waitcnt vmcnt(1)
    s_branch L_pw1
L_pw0:
    s_waitcnt vmcnt(0)
L_pw1:
    s_waitcnt vmcnt(60)
    s_mov_b64 exec, 1
    ds_add_rtn_u32 v13, v9, v8 offset:4
    s_waitcnt lgkmcnt(0)
    v_readfirstlane_b32 s35, v13
    s_mov_b64 exec, 0xffff
    s_nop 0
    s_cmp_lg_u32 s35, 3
    s_cbranch_scc1 L_nopub1
    buffer_store_dwordx2 v[4:5], v10, s[20:23], s93 offen offset:256 sc1
L_nopub1:
    s_mov_b64 exec, -1
L_red:
    s_waitcnt lgkmcnt(0)
    s_and_b32 s92, s83, 15
    s_bfe_u32 s58, s83, 0x70004
    s_bfe_u32 s59, s83, 0x3000b
    s_lshr_b32 s83, s83, 14
    s_add_u32 s1, s58, s59
    s_and_b32 s0, s83, 7
    s_add_u32 s0, s0, s58
    s_mov_b64 s[24:25], s[48:49]
    s_mov_b32 s26, 1280
    s_mov_b32 s27, 0x20000
    v_and_b32 v11, 15, v1
    v_lshrrev_b32 v12, 4, v1
    v_lshlrev_b32 v13, 3, v11
    s_lshl_b32 s92, s92, 7
    buffer_load_dwordx2 v[30:31], v13, s[24:27], s92 offen
    s_lshl_b32 s34, s101, 2
    v_add_u32 v12, s34, v12
    v_mul_u32_u24 v6, 272, v12
    v_lshl_add_u32 v6, v11, 4, v6
    v_mul_u32_u24 v7, 1280, v12
    v_add3_u32 v7, v7, v13, s92
    v_and_b32 v10, 3, v1
    v_lshlrev_b32 v10, 8, v10
    v_lshl_add_u32 v10, v1, 2, v10
    v_add_u32 v10, 156928, v10
    s_mov_b32 s96, 17408
    s_mul_i32 s59, s59, 17408
    s_mov_b32 s33, 0
    s_waitcnt vmcnt(0)
    s_mov_b64 s[24:25], s[50:51]
    s_mov_b32 s26, 2621440
    s_mov_b32 s27, 0x20000
    v_lshlrev_b32 v28, 16, v30
    v_and_b32 v29, 0xffff0000, v30
    v_lshlrev_b32 v30, 16, v31
    v_and_b32 v31, 0xffff0000, v31
L_rw:
    ds_read_b32 v11, v10
    s_add_u32 s33, s33, 1
    s_cmp_gt_u32 s33, 8000000
    s_waitcnt lgkmcnt(0)
    s_cbranch_scc1 L_rgo
    v_cmp_gt_u32 vcc, s96, v11
    s_cbranch_vccz L_rgo
    s_cmp_eq_u32 s96, s59
    s_cbranch_scc1 L_rw
    s_sleep 3
    s_branch L_rw
L_rgo:
    ds_read_b128 v[32:35], v6 offset:0
    ds_read_b128 v[36:39], v6 offset:4352
    ds_read_b128 v[40:43], v6 offset:8704
    ds_read_b128 v[44:47], v6 offset:13056
    v_add_u32 v6, 17408, v6
    s_mul_i32 s97, s0, 20480
    s_lshr_b32 s83, s83, 3
    s_and_b32 s0, s83, 7
    s_add_u32 s0, s0, s58
    s_bitcmp1_b32 s0, 1
    s_add_u32 s96, s96, 17408
    s_waitcnt lgkmcnt(3)
    v_add_f32 v32, v32, v28
    v_add_f32 v33, v33, v29
    v_add_f32 v34, v34, v30
    v_add_f32 v35, v35, v31
    s_waitcnt lgkmcnt(1)
    v_add_f32 v36, v36, v40
    v_add_f32 v37, v37, v41
    v_add_f32 v38, v38, v42
    v_add_f32 v39, v39, v43
    s_waitcnt lgkmcnt(0)
    v_add_f32 v32, v32, v44
    v_add_f32 v33, v33, v45
    v_add_f32 v34, v34, v46
    v_add_f32 v35, v35, v47
    v_add_f32 v32, v32, v36
    v_add_f32 v33, v33, v37
    v_add_f32 v34, v34, v38
    v_add_f32 v35, v35, v39
    v_cvt_pk_bf16_f32 v4, v32, v33
    v_cvt_pk_bf16_f32 v5, v34, v35
    s_cmp_le_u32 s96, s59
    buffer_store_dwordx2 v[4:5], v7, s[24:27], s97 offen nt
    s_cbranch_scc1 L_rw
    s_endpgm
L_fin:
L_end:
    s_endpgm
    .p2align 6
    .type L_table,@object
L_table:
    .long 0x8c0e890, 0x8c0e895, 0x11846a70, 0x11846a75, 0x8c0ec90, 0x8c0ec95, 0x11846e70, 0x11846e75
    .long 0x1086a8e0, 0x1086a8e5, 0xd422ac0, 0xd422ac5, 0x1086ace0, 0x1086ace5, 0xd422ec0, 0xd422ec5
    .long 0x11846930, 0x11846935, 0x8c0eb10, 0x8c0eb15, 0x11846d30, 0x11846d35, 0x8c0ef10, 0x8c0ef15
    .long 0xd422980, 0xd422985, 0x1086ab60, 0x1086ab65, 0xd422d80, 0xd422d85, 0x1086af60, 0x1086af65
    .long 0x8c0e9d0, 0x8c0e9d5, 0x11846bb0, 0x11846bb5, 0x8c0edd0, 0x8c0edd5, 0x11846fb0, 0x11846fb5
    .long 0x8c0e851, 0x8c0e856, 0x11846a71, 0x11846a76, 0x8c0ec51, 0x8c0ec56, 0x11846e71, 0x11846e76
    .long 0x1086a8a1, 0x1086a8a6, 0xd422ac1, 0xd422ac6, 0x1086aca1, 0x1086aca6, 0xd422ec1, 0xd422ec6
    .long 0x118468f1, 0x118468f6, 0x8c0eb11, 0x8c0eb16, 0x11846cf1, 0x11846cf6, 0x8c0ef11, 0x8c0ef16
    .long 0xd422941, 0xd422946, 0x1086ab61, 0x1086ab66, 0xd422d41, 0xd422d46, 0x1086af61, 0x1086af66
    .long 0x8c0e991, 0x8c0e996, 0x11846bb1, 0x11846bb6, 0x8c0ed91, 0x8c0ed96, 0x11846fb1, 0x11846fb6
    .long 0x8c0e892, 0x8c0e897, 0x11846a72, 0x11846a77, 0x8c0ec92, 0x8c0ec97, 0x11846e72, 0x11846e77
    .long 0x1086a8e2, 0x1086a8e7, 0xd422ac2, 0xd422ac7, 0x1086ace2, 0x1086ace7, 0xd422ec2, 0xd422ec7
    .long 0x11846932, 0x11846937, 0x8c0eb12, 0x8c0eb17, 0x11846d32, 0x11846d37, 0x8c0ef12, 0x8c0ef17
    .long 0xd422982, 0xd422987, 0x1086ab62, 0x1086ab67, 0xd422d82, 0xd422d87, 0x1086af62, 0x1086af67
    .long 0x8c0e9d2, 0x8c0e9d7, 0x11846bb2, 0x11846bb7, 0x8c0edd2, 0x8c0edd7, 0x11846fb2, 0x11846fb7
    .long 0x8c0e853, 0x8c0e858, 0x11846a73, 0x11846a78, 0x8c0ec53, 0x8c0ec58, 0x11846e73, 0x11846e78
    .long 0x1086a8a3, 0x1086a8a8, 0xd422ac3, 0xd422ac8, 0x1086aca3, 0x1086aca8, 0xd422ec3, 0xd422ec8
    .long 0x118468f3, 0x118468f8, 0x8c0eb13, 0x8c0eb18, 0x11846cf3, 0x11846cf8, 0x8c0ef13, 0x8c0ef18
    .long 0xd422943, 0xd422948, 0x1086ab63, 0x1086ab68, 0xd422d43, 0xd422d48, 0x1086af63, 0x1086af68
    .long 0x8c0e993, 0x8c0e998, 0x11846bb3, 0x11846bb8, 0x8c0ed93, 0x8c0ed98, 0x11846fb3, 0x11846fb8
    .long 0x1086a864, 0x1086a869, 0x1086aa64, 0x1086aa69, 0x1086ac64, 0x1086ac69, 0x1086ae64, 0x1086ae69
    .long 0x8c0e914, 0x8c0e919, 0x8c0eb14, 0x8c0eb19, 0x8c0ed14, 0x8c0ed19, 0x8c0ef14, 0x8c0ef19
    .long 0x1086a964, 0x1086a969, 0x1086ab64, 0x1086ab69, 0x1086ad64, 0x1086ad69, 0x1086af64, 0x1086af69
    .long 0x118469b4, 0x118469b9, 0x11846bb4, 0x11846bb9, 0x11846db4, 0x11846db9, 0x11846fb4, 0x11846fb9
    .long 0x1a22000, 0x1a22005, 0x86a1e1, 0x86a1e6, 0x1a22400, 0x1a22405, 0x86a5e1, 0x86a5e6
    .long 0x1a22002, 0x1a22007, 0x86a1e3, 0x86a1e8, 0x1a22402, 0x1a22407, 0x86a5e3, 0x86a5e8
    .long 0xd422801, 0xd422806, 0x1086aa20, 0x1086aa25, 0xd422c01, 0xd422c06, 0x1086ae20, 0x1086ae25
    .long 0xd422803, 0xd422808, 0x1086aa22, 0x1086aa27, 0xd422c03, 0xd422c08, 0x1086ae22, 0x1086ae27
    .long 0xd422840, 0xd422845, 0x1086aa21, 0x1086aa26, 0xd422c40, 0xd422c45, 0x1086ae21, 0x1086ae26
    .long 0xd422842, 0xd422847, 0x1086aa23, 0x1086aa28, 0xd422c42, 0xd422c47, 0x1086ae23, 0x1086ae28
    .long 0x6ac23004, 0x6ac23009, 0x6ac23204, 0x6ac23209, 0x6ac23404, 0x6ac23409, 0x6ac23604, 0x6ac23609
    .long 0x8c5470b4, 0x8c5470b9, 0x8c5472b4, 0x8c5472b9, 0x8c5474b4, 0x8c5474b9, 0x8c5476b4, 0x8c5476b9
L_codeend:
.section .rodata,"a"
.p2align 6
.amdhsa_kernel standalone__dense_activation_gelu__prompt_kernel
  .amdhsa_next_free_vgpr 256
  .amdhsa_next_free_sgpr 102
  .amdhsa_accum_offset 128
  .amdhsa_group_segment_fixed_size 0
  .amdhsa_kernarg_size 64
  .amdhsa_user_sgpr_count 2
  .amdhsa_user_sgpr_kernarg_segment_ptr 1
  .amdhsa_system_sgpr_workgroup_id_x 1
  .amdhsa_float_denorm_mode_32 3
  .amdhsa_float_denorm_mode_16_64 3
.end_amdhsa_kernel
```
